```python
import torch

def _softmax(x, axis=-1):
    return torch.softmax(x, dim=axis)

def _gelu(x):
    return torch.nn.functional.gelu(x, approximate='tanh')

def _silu(x):
    return torch.nn.functional.silu(x)

def _sigmoid(x):
    return torch.sigmoid(x)

def _layernorm(x, axis=-1, eps=1e-05):
    m = x.mean(dim=axis, keepdim=True)
    v = x.var(dim=axis, keepdim=True, unbiased=False)
    return (x - m) / torch.sqrt(v + eps)

def _scatter_add(tgt, idx, src, axis=0):
    return tgt.clone().index_add_(axis, idx, src)

def _segment_sum(src, seg, n):
    out = torch.zeros((n,) + src.shape[1:], dtype=src.dtype)
    return out.index_add_(0, seg, src)

def _pad(x, pw):
    flat = tuple((v for pair in reversed(pw) for v in pair))
    return torch.nn.functional.pad(x, flat)
kernel_name = 'adaLN_cond__sliding_block_cached__glu_gated_glu__decode'

def setup_inputs():

    _w = lambda a: (lambda t: t.to(torch.bfloat16) if t.is_floating_point() else t)(torch.as_tensor(a))

    def _A_setup():
        B, Sq, D = (4, 1, 512)
        Hq, Hkv, Sk, Dh = (32, 8, 8192, 128)
        assert Hq % Hkv == 0, (Hq, Hkv)
        return {'x': _w((lambda *s: torch.randn(*s, dtype=torch.bfloat16) * 0.05)(B, Sq, D)), 'k_cache': _w((lambda *s: torch.randn(*s, dtype=torch.bfloat16) * 3.2)(B, Hkv, Sk, Dh)), 'v_cache': _w((lambda *s: torch.randn(*s, dtype=torch.bfloat16) * 0.4)(B, Hkv, Sk, Dh)), 'wq': _w((lambda *s: torch.randn(*s, dtype=torch.bfloat16) * 3.2)(D, Hq * Dh) * D ** (-0.5)), 'wo': _w((lambda *s: torch.randn(*s, dtype=torch.bfloat16) * 0.4)(Hq * Dh, D) * (Hq * Dh) ** (-0.5))}
    _A_in = _A_setup()

    def _B_setup():
        B, S, D, F = (4, 1, 512, 1792)
        return {'x': _w((lambda *s: torch.randn(*s, dtype=torch.bfloat16) * 0.05)(B, S, D)), 'w_gate': _w((lambda *s: torch.randn(*s, dtype=torch.bfloat16) * 0.05)(D, F)), 'w_up': _w((lambda *s: torch.randn(*s, dtype=torch.bfloat16) * 0.05)(D, F)), 'w_down': _w((lambda *s: torch.randn(*s, dtype=torch.bfloat16) * 0.05)(F, D))}
    _B_in = _B_setup()
    return {'A_x': _A_in['x'], 'A_k_cache': _A_in['k_cache'], 'A_v_cache': _A_in['v_cache'], 'A_wq': _A_in['wq'], 'A_wo': _A_in['wo'], 'B_x': _B_in['x'], 'B_w_gate': _B_in['w_gate'], 'B_w_up': _B_in['w_up'], 'B_w_down': _B_in['w_down'], 'c': _w((lambda *s: torch.randn(*s, dtype=torch.bfloat16) * 0.1)(4, 512) * 8.0), 'w_mod': _w((lambda *s: torch.randn(*s, dtype=torch.bfloat16) * 0.1)(512, 6 * 512) * 512 ** (-0.5) * 8.0)}

def reference(A_x, A_k_cache, A_v_cache, A_wq, A_wo, B_x, B_w_gate, B_w_up, B_w_down, c, w_mod):

    def _A_ref(x, k_cache, v_cache, wq, wo):
        B, Sq, D = x.shape
        Hq, Dh = (32, 128)
        Hkv, Sk = (k_cache.shape[1], k_cache.shape[2])
        W = min(4096, max(256, Sk // 4))
        rep = Hq // Hkv
        q = (lambda x, *d: x.permute(*d))((x @ wq).reshape(B, Sq, Hq, Dh), 0, 2, 1, 3)
        k = (lambda x, n, axis: torch.repeat_interleave(x, n, dim=axis))(k_cache[:, :, Sk - W:, :], rep, axis=1)
        v = (lambda x, n, axis: torch.repeat_interleave(x, n, dim=axis))(v_cache[:, :, Sk - W:, :], rep, axis=1)
        scores = torch.einsum('bhqd,bhkd->bhqk', q, k) * Dh ** (-0.5)
        p = _softmax(scores, axis=-1)
        o = torch.einsum('bhqk,bhkd->bhqd', p, v)
        return (lambda x, *d: x.permute(*d))(o, 0, 2, 1, 3).reshape(B, Sq, Hq * Dh) @ wo

    def _B_ref(x, w_gate, w_up, w_down):
        g = torch.einsum('bsd,df->bsf', x, w_gate)
        u = torch.einsum('bsd,df->bsf', x, w_up)
        h = _sigmoid(g) * u
        return torch.einsum('bsf,fd->bsd', h, w_down)
    x = A_x
    mod = (_silu(c) @ w_mod).reshape(c.shape[0], 6, 1, -1)
    sa, ca, ga, sb, cb, gb = (mod[:, 0].clone(), mod[:, 1].clone(), mod[:, 2].clone(), mod[:, 3].clone(), mod[:, 4].clone(), mod[:, 5].clone())
    h = _layernorm(x, axis=-1) * (1 + ca) + sa
    x = x + ga * _A_ref(h, A_k_cache, A_v_cache, A_wq, A_wo)
    h = _layernorm(x, axis=-1) * (1 + cb) + sb
    x = x + gb * _B_ref(h, B_w_gate, B_w_up, B_w_down)
    return x
```

```asm
; @launch grid=(256,1,1) block=(320,1,1) lds=147456
.amdgcn_target "amdgcn-amd-amdhsa--gfx950"
.text
.globl adaLN_cond__sliding_block_cached__glu_gated_glu__decode_kernel
.p2align 12
.fill 832, 4, 0xbf810000
.p2align 8
.type adaLN_cond__sliding_block_cached__glu_gated_glu__decode_kernel,@function
adaLN_cond__sliding_block_cached__glu_gated_glu__decode_kernel:
    s_load_dwordx2 s[40:41], s[0:1], 8
    s_load_dwordx16 s[8:23], s[0:1], 0
    s_load_dwordx8 s[24:31], s[0:1], 64
    s_load_dwordx4 s[32:35], s[0:1], 96
    s_getpc_b64 s[70:71]
L_pc:
    s_cmpk_ge_u32 s2, 256
    s_cbranch_scc1 L_exit
    v_lshrrev_b32 v1, 6, v0
    v_and_b32 v0, 63, v0
    v_readfirstlane_b32 s3, v1
    s_and_b32 s4, s2, 7
    s_lshr_b32 s5, s2, 3
    s_lshr_b32 s6, s2, 6
    s_and_b32 s7, s5, 7
    v_and_b32 v7, 15, v0
    v_lshrrev_b32 v3, 4, v0
    v_and_b32 v4, 3, v0
    v_lshlrev_b32 v8, 4, v0
    s_cmp_eq_u32 s6, 3
    s_cselect_b32 s96, 2, 0
    s_cmp_lg_u32 s3, 4
    s_cbranch_scc1 L_main
    v_lshl_add_u32 v1, v0, 3, s7
    v_lshlrev_b32 v1, 7, v1
    v_min_u32 v1, L_last-L_pc, v1
    s_mov_b64 exec, 0xfffff
    global_load_dword v2, v1, s[70:71]
    s_mov_b64 exec, -1
    s_branch L_front
L_main:
    s_mov_b32 s43, 0x00020000
    s_mov_b32 s51, s43
    s_mov_b32 s55, s43
    s_mov_b32 s67, s43
    s_mov_b32 s63, s43
    s_mov_b32 s50, 3145728
    s_mov_b32 s42, 67108864
    s_lshl_b32 s66, s96, 11
    s_lshl_b32 s62, s96, 11
    s_lshl_b32 s82, s3, 10
    s_lshl_b32 s80, s3, 8
    v_and_b32 v6, 12, v0
    v_lshl_add_u32 v6, v6, 2, v4
    v_lshl_add_u32 v6, v6, 3, v3
    v_lshlrev_b32 v6, 3, v6
    v_lshrrev_b32 v1, 1, v0
    v_mul_u32_u24 v1, 48, v1
    v_and_or_b32 v1, v0, 1, v1
    v_lshlrev_b32 v5, 7, v1
    s_lshl2_add_u32 s99, s5, s3
    s_mul_i32 s78, s99, 96
    s_add_u32 s78, s78, s4
    s_lshl_b32 s78, s78, 8
    s_lshl3_add_u32 s79, s99, s4
    s_lshl_b32 s79, s79, 10
    s_mov_b32 s54, 4194304
    s_mov_b32 s74, 786432
    s_and_b32 s99, s5, 28
    s_add_u32 s99, s99, s3
    s_and_b32 s75, s5, 3
    s_lshl2_add_u32 s99, s99, s75
    s_lshl_b32 s75, s4, 11
    s_add_u32 s75, s75, s99
    s_add_u32 s75, s75, 50688
    s_lshl_b32 s75, s75, 10
    s_cmp_lg_u32 s96, 0
    s_mov_b64 exec, 0xff
    s_waitcnt lgkmcnt(0)
    s_mov_b64 s[48:49], s[28:29]
    s_mov_b64 s[64:65], s[26:27]
    s_mov_b64 s[60:61], s[8:9]
    s_mov_b64 s[52:53], s[14:15]
    buffer_load_dword v23, v5, s[48:51], s78 offen
    s_mov_b64 exec, -1
    s_cbranch_scc0 L_help
    buffer_load_dwordx2 v[24:25], v6, s[64:67], s80 offen
    buffer_load_dwordx2 v[26:27], v6, s[64:67], s80 offen offset:32
    buffer_load_dwordx4 v[28:31], v8, s[60:63], s82 offen
    s_branch L_qcu
L_help:
    buffer_load_dwordx4 v[196:199], v8, s[52:55], s79 offen
    s_add_u32 s79, s79, s74
    buffer_load_dwordx4 v[196:199], v8, s[52:55], s79 offen
    s_add_u32 s79, s79, s74
    buffer_load_dwordx4 v[196:199], v8, s[52:55], s79 offen
    s_add_u32 s79, s79, s74
    buffer_load_dwordx4 v[196:199], v8, s[52:55], s79 offen
    s_add_u32 s79, s79, s74
    buffer_load_dwordx4 v[196:199], v8, s[52:55], s79 offen
    s_mov_b32 s79, s75
    s_lshr_b32 s74, s74, 3
    s_waitcnt vmcnt(5)
    buffer_load_dwordx4 v[196:199], v8, s[40:43], s79 offen
    s_add_u32 s79, s79, s74
    buffer_load_dwordx4 v[196:199], v8, s[40:43], s79 offen
    s_add_u32 s79, s79, s74
    buffer_load_dwordx4 v[196:199], v8, s[40:43], s79 offen
    s_add_u32 s79, s79, s74
    s_waitcnt vmcnt(7)
    buffer_load_dwordx4 v[196:199], v8, s[40:43], s79 offen
    s_add_u32 s79, s79, s74
    s_waitcnt vmcnt(7)
    buffer_load_dwordx4 v[196:199], v8, s[40:43], s79 offen
    s_mov_b32 s79, s75
    s_waitcnt vmcnt(7)
    s_mov_b64 s[44:45], s[12:13]
    s_mov_b64 s[46:47], s[42:43]
    buffer_load_dwordx4 v[196:199], v8, s[44:47], s79 offen
    s_add_u32 s79, s79, s74
    s_waitcnt vmcnt(7)
    buffer_load_dwordx4 v[196:199], v8, s[44:47], s79 offen
    s_add_u32 s79, s79, s74
    s_waitcnt vmcnt(7)
    buffer_load_dwordx4 v[196:199], v8, s[44:47], s79 offen
    s_mov_b32 s83, 0xffff0000
    s_lshl_b32 s98, s3, 12
    s_lshl3_add_u32 s76, s6, s4
    s_lshl_b32 s76, s76, 7
    s_add_u32 s76, s76, s7
    s_lshl2_add_u32 s76, s76, s3
    s_addk_i32 s76, 384
    s_lshl_b32 s76, s76, 12
    v_bfe_u32 v1, v0, 2, 2
    v_lshl_add_u32 v1, v1, 4, v3
    v_lshl_add_u32 v1, v1, 2, v4
    v_lshlrev_b32 v2, 4, v1
    s_waitcnt vmcnt(7)
    buffer_load_dwordx4 v[64:67], v2, s[40:43], s76 offen offset:0 nt
    s_waitcnt vmcnt(7)
    buffer_load_dwordx4 v[68:71], v2, s[40:43], s76 offen offset:256 nt
    s_waitcnt vmcnt(7)
    buffer_load_dwordx4 v[72:75], v2, s[40:43], s76 offen offset:512 nt
    s_waitcnt vmcnt(7)
    buffer_load_dwordx4 v[76:79], v2, s[40:43], s76 offen offset:768 nt
    s_waitcnt vmcnt(7)
    s_add_u32 s97, s76, 131072
    buffer_load_dwordx4 v[80:83], v2, s[40:43], s97 offen offset:0 nt
    s_waitcnt vmcnt(7)
    buffer_load_dwordx4 v[84:87], v2, s[40:43], s97 offen offset:256 nt
    s_waitcnt vmcnt(7)
    buffer_load_dwordx4 v[88:91], v2, s[40:43], s97 offen offset:512 nt
    s_waitcnt vmcnt(7)
    buffer_load_dwordx4 v[92:95], v2, s[40:43], s97 offen offset:768 nt
    s_waitcnt vmcnt(7)
L_stream:
    s_add_u32 s97, s76, 262144
    buffer_load_dwordx4 v[96:99], v2, s[40:43], s97 offen offset:0 nt
    s_waitcnt vmcnt(7)
    buffer_load_dwordx4 v[100:103], v2, s[40:43], s97 offen offset:256 nt
    s_mov_b64 s[44:45], s[12:13]
    s_mov_b32 s46, 67108864
    s_mov_b32 s47, s43
    s_mov_b64 s[36:37], s[34:35]
    s_mov_b32 s38, 268435456
    s_mov_b32 s39, s43
    s_mov_b64 s[60:61], s[8:9]
    s_mov_b32 s62, 4096
    s_mov_b32 s63, s43
    v_lshlrev_b32 v1, 1, v3
    v_xor_b32 v1, v1, v7
    v_lshlrev_b32 v1, 4, v1
    v_lshl_add_u32 v5, v3, 8, v1
    v_xor_b32 v6, 0x80, v5
    v_bfe_u32 v1, v0, 2, 2
    v_lshlrev_b32 v9, 8, v4
    v_lshl_add_u32 v9, v3, 6, v9
    v_lshl_add_u32 v9, v1, 4, v9
    v_add_u32 v9, 131072, v9
    v_lshlrev_b32 v14, 4, v4
    v_add_u32 v14, 131072, v14
    v_lshl_add_u32 v13, s3, 2, v14
    v_lshl_add_u32 v16, v3, 6, v14
    v_add_u32 v16, 9216, v16
    v_lshl_add_u32 v15, v1, 9, v16
    s_lshr_b32 s77, s3, 1
    s_lshl_b32 s77, s77, 8
    s_and_b32 s78, s3, 1
    s_lshl3_add_u32 s77, s78, s77
    v_add_u32 v15, s77, v15
    s_waitcnt vmcnt(7)
    buffer_load_dwordx4 v[104:107], v2, s[40:43], s97 offen offset:512 nt
    s_waitcnt vmcnt(7)
    buffer_load_dwordx4 v[108:111], v2, s[40:43], s97 offen offset:768 nt
    v_lshrrev_b32 v10, 2, v0
    v_and_b32 v18, 7, v10
    s_lshl_b32 s77, s3, 1
    v_xor_b32 v18, s77, v18
    v_lshlrev_b32 v18, 5, v18
    v_lshl_add_u32 v17, v10, 8, v18
    v_lshl_add_u32 v17, v4, 3, v17
    v_xor_b32 v18, 32, v17
    v_lshlrev_b32 v19, 8, v4
    s_lshl_b32 s82, s4, 16
    s_lshl3_add_u32 s81, s5, s82
    s_add_u32 s81, s81, 1085440
    v_lshlrev_b32 v20, 13, v4
    v_lshl_add_u32 v20, v3, 8, v20
    s_lshr_b32 s77, s7, 2
    s_lshl1_add_u32 s77, s3, s77
    s_lshl4_add_u32 s77, s77, s6
    s_and_b32 s78, s7, 3
    s_lshl2_add_u32 s77, s77, s78
    s_lshl4_add_u32 s82, s77, s82
    s_add_u32 s82, s82, 1048576
    s_waitcnt vmcnt(7)
    s_add_u32 s97, s76, 393216
    buffer_load_dwordx4 v[112:115], v2, s[40:43], s97 offen offset:0 nt
    s_waitcnt vmcnt(7)
    buffer_load_dwordx4 v[116:119], v2, s[40:43], s97 offen offset:256 nt
    v_and_b32 v12, 1, v3
    v_lshlrev_b32 v1, 1, v12
    v_xor_b32 v1, v1, v4
    v_lshlrev_b32 v11, 4, v1
    s_mov_b32 s72, 0
    s_waitcnt vmcnt(7)
    buffer_load_dwordx4 v[120:123], v2, s[40:43], s97 offen offset:512 nt
    s_waitcnt vmcnt(7)
    buffer_load_dwordx4 v[124:127], v2, s[40:43], s97 offen offset:768 nt
    s_waitcnt vmcnt(7)
    s_add_u32 m0, s98, 0
    s_add_u32 s97, s76, 0
    buffer_load_dwordx4 v5, s[44:47], s97 offen offset:0 nt lds
    s_cmp_ge_u32 s5, 24
    s_cbranch_scc1 L_su_m
    s_cmp_ge_u32 s5, 16
    s_cbranch_scc1 L_su_g
    s_branch L_su_w
L_su_done:
    v_mul_lo_u32 v10, v10, s78
    v_add_u32 v10, v10, v11
    v_xor_b32 v11, 16, v10
    s_lshl_b32 s74, s78, 4
    s_sub_u32 s74, s74, 1024
    s_and_b32 s77, s5, 1
    s_lshl1_add_u32 s77, s3, s77
    s_lshl_b32 s80, s77, 12
    s_add_u32 s80, s80, 65536
    s_xor_b32 s8, s80, 4096
    s_lshl_b32 s78, s78, 6
    s_xor_b32 s75, s77, 1
    s_mul_i32 s75, s75, s78
    s_add_u32 s75, s75, s79
    s_mul_i32 s77, s77, s78
    s_add_u32 s79, s79, s77
    s_waitcnt vmcnt(7)
    buffer_load_dwordx4 v6, s[44:47], s97 offen offset:1024 nt lds
    s_lshl_b32 s9, s4, 19
    s_movk_i32 s77, 1024
    s_mov_b64 s[40:41], s[16:17]
    s_mov_b32 s42, 4194304
    s_lshl_b32 s72, s4, 9
    s_and_b32 s78, s4, 1
    s_cselect_b32 s10, 0, 3145728
    s_add_u32 s11, s72, 2048
    s_cmp_eq_u32 s3, 1
    s_cselect_b64 s[40:41], s[28:29], s[40:41]
    s_cselect_b32 s42, s10, s42
    s_cselect_b32 s9, s11, s9
    s_cselect_b32 s77, 6144, s77
    s_cmp_eq_u32 s4, 7
    s_cselect_b32 s10, 0, 1835008
    s_cmp_eq_u32 s3, 2
    s_cselect_b64 s[14:15], s[20:21], s[22:23]
    s_cmp_ge_u32 s3, 2
    s_cselect_b64 s[40:41], s[14:15], s[40:41]
    s_cselect_b32 s42, s10, s42
    s_cselect_b32 s9, s72, s9
    s_cselect_b32 s77, 3584, s77
    v_mul_lo_u32 v229, v7, s77
    s_mul_i32 s77, s77, s5
    s_lshl4_add_u32 s9, s77, s9
    s_addk_i32 s9, 384
    s_waitcnt vmcnt(7)
    buffer_load_dwordx4 v5, s[44:47], s97 offen offset:2048 nt lds
    s_waitcnt vmcnt(7)
    buffer_load_dwordx4 v6, s[44:47], s97 offen offset:3072 nt lds
    s_waitcnt vmcnt(7)
    s_add_u32 m0, s98, 16384
    s_add_u32 s97, s76, 131072
    buffer_load_dwordx4 v5, s[44:47], s97 offen offset:0 nt lds
    s_waitcnt vmcnt(7)
    buffer_load_dwordx4 v6, s[44:47], s97 offen offset:1024 nt lds
    s_waitcnt vmcnt(7)
    buffer_load_dwordx4 v5, s[44:47], s97 offen offset:2048 nt lds
    s_waitcnt vmcnt(7)
    buffer_load_dwordx4 v6, s[44:47], s97 offen offset:3072 nt lds
    s_waitcnt vmcnt(7)
    s_add_u32 m0, s98, 32768
    s_add_u32 s97, s76, 262144
    buffer_load_dwordx4 v5, s[44:47], s97 offen offset:0 nt lds
    s_waitcnt vmcnt(7)
    buffer_load_dwordx4 v6, s[44:47], s97 offen offset:1024 nt lds
    s_waitcnt vmcnt(7)
    buffer_load_dwordx4 v5, s[44:47], s97 offen offset:2048 nt lds
    s_waitcnt vmcnt(7)
    buffer_load_dwordx4 v6, s[44:47], s97 offen offset:3072 nt lds
    s_waitcnt vmcnt(7)
    s_add_u32 m0, s98, 49152
    s_add_u32 s97, s76, 393216
    buffer_load_dwordx4 v5, s[44:47], s97 offen offset:0 nt lds
    s_waitcnt vmcnt(7)
    buffer_load_dwordx4 v6, s[44:47], s97 offen offset:1024 nt lds
    s_waitcnt vmcnt(7)
    buffer_load_dwordx4 v5, s[44:47], s97 offen offset:2048 nt lds
    s_waitcnt vmcnt(7)
    buffer_load_dwordx4 v6, s[44:47], s97 offen offset:3072 nt lds
    s_waitcnt vmcnt(16)
    s_barrier
    ds_read_b128 v[32:35], v9
    ds_read_b64 v[60:61], v14 offset:14464
    s_waitcnt lgkmcnt(0)
    v_mfma_f32_16x16x32_bf16 v[128:131], v[64:67], v[32:35], 0
    v_mfma_f32_16x16x32_bf16 v[132:135], v[68:71], v[32:35], 0
    v_readfirstlane_b32 s73, v60
    s_nop 0
    s_and_b32 s73, s73, 1
    v_mfma_f32_16x16x32_bf16 v[136:139], v[72:75], v[32:35], 0
    v_mfma_f32_16x16x32_bf16 v[140:143], v[76:79], v[32:35], 0
    v_mfma_f32_16x16x32_bf16 v[144:147], v[80:83], v[32:35], 0
    v_mfma_f32_16x16x32_bf16 v[148:151], v[84:87], v[32:35], 0
    v_add_f32_dpp v36, v129, v128 row_ror:12 row_mask:0xf bank_mask:0x1
    v_add_f32_dpp v37, v133, v132 row_ror:12 row_mask:0xf bank_mask:0x1
    s_nop 2
    v_add_f32_dpp v38, v137, v136 row_ror:12 row_mask:0xf bank_mask:0x1
    v_mfma_f32_16x16x32_bf16 v[152:155], v[88:91], v[32:35], 0
    v_add_f32_dpp v39, v141, v140 row_ror:12 row_mask:0xf bank_mask:0x1
    v_add_f32_dpp v36, v130, v36 row_ror:8 row_mask:0xf bank_mask:0x1
    v_add_f32_dpp v37, v134, v37 row_ror:8 row_mask:0xf bank_mask:0x1
    v_mfma_f32_16x16x32_bf16 v[156:159], v[92:95], v[32:35], 0
    v_add_f32_dpp v38, v138, v38 row_ror:8 row_mask:0xf bank_mask:0x1
    v_add_f32_dpp v39, v142, v39 row_ror:8 row_mask:0xf bank_mask:0x1
    v_add_f32_dpp v36, v131, v36 row_ror:4 row_mask:0xf bank_mask:0x1
    v_mfma_f32_16x16x32_bf16 v[160:163], v[96:99], v[32:35], 0
    v_add_f32_dpp v37, v135, v37 row_ror:4 row_mask:0xf bank_mask:0x1
    v_add_f32_dpp v38, v139, v38 row_ror:4 row_mask:0xf bank_mask:0x1
    v_add_f32_dpp v39, v143, v39 row_ror:4 row_mask:0xf bank_mask:0x1
    v_mfma_f32_16x16x32_bf16 v[164:167], v[100:103], v[32:35], 0
    v_add_f32_dpp v36, v144, v145 row_ror:4 row_mask:0xf bank_mask:0x2
    v_add_f32_dpp v37, v148, v149 row_ror:4 row_mask:0xf bank_mask:0x2
    v_add_f32_dpp v38, v152, v153 row_ror:4 row_mask:0xf bank_mask:0x2
    v_mfma_f32_16x16x32_bf16 v[168:171], v[104:107], v[32:35], 0
    v_add_f32_dpp v39, v156, v157 row_ror:4 row_mask:0xf bank_mask:0x2
    v_add_f32_dpp v36, v146, v36 row_ror:12 row_mask:0xf bank_mask:0x2
    v_add_f32_dpp v37, v150, v37 row_ror:12 row_mask:0xf bank_mask:0x2
    v_mfma_f32_16x16x32_bf16 v[172:175], v[108:111], v[32:35], 0
    v_add_f32_dpp v38, v154, v38 row_ror:12 row_mask:0xf bank_mask:0x2
    v_add_f32_dpp v39, v158, v39 row_ror:12 row_mask:0xf bank_mask:0x2
    v_add_f32_dpp v36, v147, v36 row_ror:8 row_mask:0xf bank_mask:0x2
    v_mfma_f32_16x16x32_bf16 v[176:179], v[112:115], v[32:35], 0
    v_add_f32_dpp v37, v151, v37 row_ror:8 row_mask:0xf bank_mask:0x2
    v_add_f32_dpp v38, v155, v38 row_ror:8 row_mask:0xf bank_mask:0x2
    v_add_f32_dpp v39, v159, v39 row_ror:8 row_mask:0xf bank_mask:0x2
    v_mfma_f32_16x16x32_bf16 v[180:183], v[116:119], v[32:35], 0
    v_add_f32_dpp v36, v160, v162 row_ror:8 row_mask:0xf bank_mask:0x4
    v_add_f32_dpp v37, v164, v166 row_ror:8 row_mask:0xf bank_mask:0x4
    v_add_f32_dpp v38, v168, v170 row_ror:8 row_mask:0xf bank_mask:0x4
    v_mfma_f32_16x16x32_bf16 v[184:187], v[120:123], v[32:35], 0
    v_add_f32_dpp v39, v172, v174 row_ror:8 row_mask:0xf bank_mask:0x4
    v_add_f32_dpp v36, v161, v36 row_ror:4 row_mask:0xf bank_mask:0x4
    v_add_f32_dpp v37, v165, v37 row_ror:4 row_mask:0xf bank_mask:0x4
    v_mfma_f32_16x16x32_bf16 v[188:191], v[124:127], v[32:35], 0
    v_add_f32_dpp v38, v169, v38 row_ror:4 row_mask:0xf bank_mask:0x4
    v_add_f32_dpp v39, v173, v39 row_ror:4 row_mask:0xf bank_mask:0x4
    v_add_f32_dpp v36, v163, v36 row_ror:12 row_mask:0xf bank_mask:0x4
    v_add_f32_dpp v37, v167, v37 row_ror:12 row_mask:0xf bank_mask:0x4
    v_add_f32_dpp v38, v171, v38 row_ror:12 row_mask:0xf bank_mask:0x4
    v_add_f32_dpp v39, v175, v39 row_ror:12 row_mask:0xf bank_mask:0x4
    v_add_f32_dpp v36, v176, v179 row_ror:12 row_mask:0xf bank_mask:0x8
    v_add_f32_dpp v37, v180, v183 row_ror:12 row_mask:0xf bank_mask:0x8
    v_add_f32_dpp v38, v184, v187 row_ror:12 row_mask:0xf bank_mask:0x8
    v_add_f32_dpp v39, v188, v191 row_ror:12 row_mask:0xf bank_mask:0x8
    v_add_f32_dpp v36, v177, v36 row_ror:8 row_mask:0xf bank_mask:0x8
    v_add_f32_dpp v37, v181, v37 row_ror:8 row_mask:0xf bank_mask:0x8
    v_add_f32_dpp v38, v185, v38 row_ror:8 row_mask:0xf bank_mask:0x8
    v_add_f32_dpp v39, v189, v39 row_ror:8 row_mask:0xf bank_mask:0x8
    v_add_f32_dpp v36, v178, v36 row_ror:4 row_mask:0xf bank_mask:0x8
    v_add_f32_dpp v37, v182, v37 row_ror:4 row_mask:0xf bank_mask:0x8
    v_add_f32_dpp v38, v186, v38 row_ror:4 row_mask:0xf bank_mask:0x8
    v_add_f32_dpp v39, v190, v39 row_ror:4 row_mask:0xf bank_mask:0x8
    v_cvt_pk_bf16_f32 v40, v36, v37
    v_cvt_pk_bf16_f32 v41, v38, v39
    v_lshlrev_b32 v36, 16, v40
    v_and_b32 v37, s83, v40
    v_lshlrev_b32 v38, 16, v41
    v_and_b32 v39, s83, v41
    v_mul_f32 v36, 0x3db504f3, v36
    v_mul_f32 v37, 0x3db504f3, v37
    v_mul_f32 v38, 0x3db504f3, v38
    v_mul_f32 v39, 0x3db504f3, v39
    v_cvt_pk_bf16_f32 v40, v36, v37
    v_cvt_pk_bf16_f32 v41, v38, v39
    v_lshlrev_b32 v36, 16, v40
    v_and_b32 v37, s83, v40
    v_lshlrev_b32 v38, 16, v41
    v_and_b32 v39, s83, v41
    v_max3_f32 v42, v36, v37, v38
    v_max_f32 v42, v42, v39
    s_nop 1
    v_max_f32_dpp v42, v42, v42 row_ror:4 row_mask:0xf bank_mask:0xf
    s_nop 1
    v_max_f32_dpp v42, v42, v42 row_ror:8 row_mask:0xf bank_mask:0xf
    v_mov_b32 v43, v42
    s_nop 1
    v_permlane16_swap_b32 v42, v43
    v_max_f32 v42, v42, v43
    v_mov_b32 v43, v42
    s_nop 1
    v_permlane32_swap_b32 v42, v43
    v_max_f32 v42, v42, v43
    ds_write_b32 v13, v42 offset:14336
    s_mov_b64 exec, 0xffff
    buffer_load_dword v228, v229, s[40:43], s9 offen
    s_mov_b64 exec, -1
    s_add_u32 m0, s80, 0
    s_nop 0
    buffer_load_dwordx4 v10, s[48:51], s79 offen offset:0 lds
    s_add_u32 s97, s79, s74
    buffer_load_dwordx4 v10, s[48:51], s97 offen offset:1024 lds
    s_add_u32 s97, s97, s74
    s_waitcnt vmcnt(11) lgkmcnt(0)
    s_barrier
    ds_read_b128 v[44:47], v14 offset:14336
    ds_read_b64_tr_b16 v[128:129], v17 offset:0
    ds_read_b64_tr_b16 v[130:131], v17 offset:4096
    ds_read_b64_tr_b16 v[132:133], v18 offset:0
    ds_read_b64_tr_b16 v[134:135], v18 offset:4096
    ds_read_b64_tr_b16 v[136:137], v17 offset:8192
    ds_read_b64_tr_b16 v[138:139], v17 offset:12288
    ds_read_b64_tr_b16 v[140:141], v18 offset:8192
    ds_read_b64_tr_b16 v[142:143], v18 offset:12288
    ds_read_b64_tr_b16 v[144:145], v17 offset:16384
    ds_read_b64_tr_b16 v[146:147], v17 offset:20480
    ds_read_b64_tr_b16 v[148:149], v18 offset:16384
    ds_read_b64_tr_b16 v[150:151], v18 offset:20480
    s_waitcnt lgkmcnt(12)
    v_max3_f32 v42, v44, v45, v46
    v_max_f32 v42, v42, v47
    v_sub_f32 v36, v36, v42
    v_sub_f32 v37, v37, v42
    v_sub_f32 v38, v38, v42
    v_sub_f32 v39, v39, v42
    v_mul_f32 v36, 0x3fb8aa3b, v36
    v_mul_f32 v37, 0x3fb8aa3b, v37
    v_mul_f32 v38, 0x3fb8aa3b, v38
    v_mul_f32 v39, 0x3fb8aa3b, v39
    v_exp_f32 v36, v36
    v_exp_f32 v37, v37
    v_exp_f32 v38, v38
    v_exp_f32 v39, v39
    v_cvt_pk_bf16_f32 v40, v36, v37
    v_cvt_pk_bf16_f32 v41, v38, v39
    ds_write_b64 v15, v[40:41]
    s_waitcnt lgkmcnt(9)
    ds_read_b64_tr_b16 v[152:153], v17 offset:24576
    ds_read_b64_tr_b16 v[154:155], v17 offset:28672
    ds_read_b64_tr_b16 v[156:157], v18 offset:24576
    ds_read_b64_tr_b16 v[158:159], v18 offset:28672
    v_add_f32 v36, v36, v37
    v_add_f32 v38, v38, v39
    s_waitcnt vmcnt(7)
    s_waitcnt lgkmcnt(4)
    s_barrier
    ds_read_b128 v[64:67], v16 offset:0
    ds_read_b128 v[68:71], v16 offset:256
    ds_read_b128 v[72:75], v16 offset:512
    ds_read_b128 v[76:79], v16 offset:768
    ds_read_b64_tr_b16 v[160:161], v17 offset:32768
    ds_read_b64_tr_b16 v[162:163], v17 offset:36864
    ds_read_b64_tr_b16 v[164:165], v18 offset:32768
    ds_read_b64_tr_b16 v[166:167], v18 offset:36864
    ds_read_b128 v[80:83], v16 offset:1024
    v_add_f32 v36, v36, v38
    s_nop 1
    v_add_f32_dpp v36, v36, v36 row_ror:4 row_mask:0xf bank_mask:0xf
    s_nop 1
    v_add_f32_dpp v36, v36, v36 row_ror:8 row_mask:0xf bank_mask:0xf
    v_mov_b32 v37, v36
    s_nop 1
    v_permlane16_swap_b32 v36, v37
    v_add_f32 v36, v36, v37
    v_mov_b32 v37, v36
    s_nop 1
    v_permlane32_swap_b32 v36, v37
    v_add_f32 v36, v36, v37
    s_waitcnt lgkmcnt(7)
    v_mfma_f32_16x16x32_bf16 v[48:51], v[128:131], v[64:67], 0
    v_mfma_f32_16x16x32_bf16 v[52:55], v[132:135], v[64:67], 0
    ds_read_b64_tr_b16 v[168:169], v17 offset:40960
    ds_read_b64_tr_b16 v[170:171], v17 offset:45056
    ds_read_b64_tr_b16 v[172:173], v18 offset:40960
    ds_read_b64_tr_b16 v[174:175], v18 offset:45056
    v_mfma_f32_16x16x32_bf16 v[48:51], v[136:139], v[68:71], v[48:51]
    v_mfma_f32_16x16x32_bf16 v[52:55], v[140:143], v[68:71], v[52:55]
    ds_read_b128 v[84:87], v16 offset:1280
    ds_read_b128 v[88:91], v16 offset:1536
    ds_read_b128 v[92:95], v16 offset:1792
    s_waitcnt lgkmcnt(12)
    ds_write_b32 v13, v36 offset:14400
    v_mfma_f32_16x16x32_bf16 v[48:51], v[144:147], v[72:75], v[48:51]
    v_mfma_f32_16x16x32_bf16 v[52:55], v[148:151], v[72:75], v[52:55]
    v_mfma_f32_16x16x32_bf16 v[48:51], v[152:155], v[76:79], v[48:51]
    v_mfma_f32_16x16x32_bf16 v[52:55], v[156:159], v[76:79], v[52:55]
    s_waitcnt lgkmcnt(8)
    v_mfma_f32_16x16x32_bf16 v[48:51], v[160:163], v[80:83], v[48:51]
    v_mfma_f32_16x16x32_bf16 v[52:55], v[164:167], v[80:83], v[52:55]
    s_waitcnt lgkmcnt(3)
    v_mfma_f32_16x16x32_bf16 v[48:51], v[168:171], v[84:87], v[48:51]
    v_mfma_f32_16x16x32_bf16 v[52:55], v[172:175], v[84:87], v[52:55]
    s_waitcnt vmcnt(3) lgkmcnt(0)
    s_barrier
    ds_read_b64_tr_b16 v[176:177], v17 offset:49152
    ds_read_b64_tr_b16 v[178:179], v17 offset:53248
    ds_read_b64_tr_b16 v[180:181], v18 offset:49152
    ds_read_b64_tr_b16 v[182:183], v18 offset:53248
    ds_read_b64_tr_b16 v[184:185], v17 offset:57344
    ds_read_b64_tr_b16 v[186:187], v17 offset:61440
    ds_read_b64_tr_b16 v[188:189], v18 offset:57344
    ds_read_b64_tr_b16 v[190:191], v18 offset:61440
    ds_read_b128 v[44:47], v14 offset:14400
    s_waitcnt lgkmcnt(5)
    v_mfma_f32_16x16x32_bf16 v[48:51], v[176:179], v[88:91], v[48:51]
    v_mfma_f32_16x16x32_bf16 v[52:55], v[180:183], v[88:91], v[52:55]
    s_waitcnt lgkmcnt(1)
    v_mfma_f32_16x16x32_bf16 v[48:51], v[184:187], v[92:95], v[48:51]
    v_mfma_f32_16x16x32_bf16 v[52:55], v[188:191], v[92:95], v[52:55]
    s_waitcnt lgkmcnt(0)
    v_add_f32 v44, v44, v45
    v_add_f32 v46, v46, v47
    s_lshl_b64 exec, 1, s3
    v_add_f32 v43, v44, v46
    s_cmp_eq_u32 s73, 0
    s_cbranch_scc1 L_ls_1
    buffer_store_dwordx2 v[42:43], v19, s[36:39], s81 offen
L_ls_2:
    s_mov_b32 exec_lo, 0xf000f
    s_mov_b32 exec_hi, 0xf000f
    v_cvt_pk_bf16_f32 v56, v48, v49
    v_cvt_pk_bf16_f32 v57, v50, v51
    v_cvt_pk_bf16_f32 v58, v52, v53
    v_cvt_pk_bf16_f32 v59, v54, v55
    s_cmp_eq_u32 s73, 0
    s_cbranch_scc1 L_ls_3
    buffer_store_dwordx4 v[56:59], v20, s[36:39], s82 offen
L_ls_4:
    s_mov_b64 exec, -1
    s_barrier
    buffer_load_dwordx4 v10, s[48:51], s97 offen offset:2048 lds
    s_add_u32 s97, s97, s74
    buffer_load_dwordx4 v10, s[48:51], s97 offen offset:3072 lds
L_have:
    s_barrier
    s_cmp_eq_u32 s96, 1
    s_cbranch_scc1 L_role_g
L_second:
    s_add_u32 m0, s8, 0
    s_nop 0
    buffer_load_dwordx4 v10, s[48:51], s75 offen offset:0 lds
    s_add_u32 s97, s75, s74
    buffer_load_dwordx4 v10, s[48:51], s97 offen offset:1024 lds
    s_add_u32 s97, s97, s74
    buffer_load_dwordx4 v10, s[48:51], s97 offen offset:2048 lds
    s_add_u32 s97, s97, s74
    buffer_load_dwordx4 v10, s[48:51], s97 offen offset:3072 lds
    s_cmp_eq_u32 s96, 2
    s_cbranch_scc1 L_role_m
    s_waitcnt vmcnt(4)
    s_barrier
    buffer_load_dwordx2 v[50:51], v21, s[36:39], s65 offen sc1
    buffer_load_dwordx4 v[64:67], v8, s[36:39], s66 offen offset:0 sc1
    buffer_load_dwordx4 v[68:71], v8, s[36:39], s66 offen offset:1024 sc1
    buffer_load_dwordx4 v[72:75], v8, s[36:39], s66 offen offset:2048 sc1
    buffer_load_dwordx4 v[76:79], v8, s[36:39], s66 offen offset:3072 sc1
    buffer_load_dwordx4 v[80:83], v8, s[36:39], s67 offen offset:0 sc1
    buffer_load_dwordx4 v[84:87], v8, s[36:39], s67 offen offset:1024 sc1
    buffer_load_dwordx4 v[88:91], v8, s[36:39], s67 offen offset:2048 sc1
    buffer_load_dwordx4 v[92:95], v8, s[36:39], s67 offen offset:3072 sc1
    s_mov_b32 s78, 0
    s_waitcnt vmcnt(9)
    ds_read_b64_tr_b16 v[96:97], v22 offset:0
    ds_read_b64_tr_b16 v[98:99], v22 offset:1024
    ds_read_b64_tr_b16 v[100:101], v22 offset:2048
    ds_read_b64_tr_b16 v[102:103], v22 offset:3072
    ds_read_b64_tr_b16 v[104:105], v22 offset:4096
    ds_read_b64_tr_b16 v[106:107], v22 offset:5120
    ds_read_b64_tr_b16 v[108:109], v22 offset:6144
    ds_read_b64_tr_b16 v[110:111], v22 offset:7168
    s_waitcnt lgkmcnt(4)
    ds_read_b64_tr_b16 v[112:113], v23 offset:0
    ds_read_b64_tr_b16 v[114:115], v23 offset:1024
    ds_read_b64_tr_b16 v[116:117], v23 offset:2048
    ds_read_b64_tr_b16 v[118:119], v23 offset:3072
    ds_read_b64_tr_b16 v[120:121], v23 offset:4096
    ds_read_b64_tr_b16 v[122:123], v23 offset:5120
    ds_read_b64_tr_b16 v[124:125], v23 offset:6144
    ds_read_b64_tr_b16 v[126:127], v23 offset:7168
    s_waitcnt vmcnt(8)
    v_max_f32_dpp v52, v50, v50 quad_perm:[1,0,3,2] row_mask:0xf bank_mask:0xf
    s_nop 1
    v_max_f32_dpp v52, v52, v52 quad_perm:[2,3,0,1] row_mask:0xf bank_mask:0xf
    s_nop 1
    v_max_f32_dpp v52, v52, v52 row_ror:4 row_mask:0xf bank_mask:0xf
    v_sub_f32 v52, v50, v52
    v_mul_f32 v52, 0x3fb8aa3b, v52
    v_exp_f32 v52, v52
    s_nop 0
    v_mul_f32 v53, v52, v51
    s_nop 1
    v_add_f32_dpp v53, v53, v53 quad_perm:[1,0,3,2] row_mask:0xf bank_mask:0xf
    s_nop 1
    v_add_f32_dpp v53, v53, v53 quad_perm:[2,3,0,1] row_mask:0xf bank_mask:0xf
    s_nop 1
    v_add_f32_dpp v53, v53, v53 row_ror:4 row_mask:0xf bank_mask:0xf
    v_rcp_f32 v53, v53
    s_nop 0
    v_mul_f32 v52, v52, v53
    s_waitcnt lgkmcnt(0)
    s_waitcnt vmcnt(7)
    v_mfma_f32_16x16x32_bf16 v[32:35], v[64:67], v[96:99], 0
    v_mfma_f32_16x16x32_bf16 v[40:43], v[64:67], v[112:115], 0
    s_waitcnt vmcnt(6)
    v_mfma_f32_16x16x32_bf16 v[36:39], v[68:71], v[96:99], 0
    v_mfma_f32_16x16x32_bf16 v[44:47], v[68:71], v[112:115], 0
    s_waitcnt vmcnt(5)
    v_mfma_f32_16x16x32_bf16 v[32:35], v[72:75], v[100:103], v[32:35]
    v_mfma_f32_16x16x32_bf16 v[40:43], v[72:75], v[116:119], v[40:43]
    s_waitcnt vmcnt(4)
    v_mfma_f32_16x16x32_bf16 v[36:39], v[76:79], v[100:103], v[36:39]
    v_mfma_f32_16x16x32_bf16 v[44:47], v[76:79], v[116:119], v[44:47]
    s_waitcnt vmcnt(3)
    v_mfma_f32_16x16x32_bf16 v[32:35], v[80:83], v[104:107], v[32:35]
    v_mfma_f32_16x16x32_bf16 v[40:43], v[80:83], v[120:123], v[40:43]
    s_waitcnt vmcnt(2)
    v_mfma_f32_16x16x32_bf16 v[36:39], v[84:87], v[104:107], v[36:39]
    v_mfma_f32_16x16x32_bf16 v[44:47], v[84:87], v[120:123], v[44:47]
    s_waitcnt vmcnt(1)
    v_mfma_f32_16x16x32_bf16 v[32:35], v[88:91], v[108:111], v[32:35]
    v_mfma_f32_16x16x32_bf16 v[40:43], v[88:91], v[124:127], v[40:43]
    s_waitcnt vmcnt(0)
    v_mfma_f32_16x16x32_bf16 v[36:39], v[92:95], v[108:111], v[36:39]
    v_mfma_f32_16x16x32_bf16 v[44:47], v[92:95], v[124:127], v[44:47]
    s_nop 3
    v_mul_f32_dpp v48, v52, v32 row_newbcast:0 row_mask:0xf bank_mask:0xf
    v_mul_f32_dpp v49, v52, v40 row_newbcast:0 row_mask:0xf bank_mask:0xf
    s_nop 0
    v_mul_f32_dpp v58, v52, v36 row_newbcast:4 row_mask:0xf bank_mask:0xf
    v_mul_f32_dpp v59, v52, v44 row_newbcast:4 row_mask:0xf bank_mask:0xf
    v_fmac_f32_dpp v48, v52, v33 row_newbcast:1 row_mask:0xf bank_mask:0xf
    v_fmac_f32_dpp v49, v52, v41 row_newbcast:1 row_mask:0xf bank_mask:0xf
    v_fmac_f32_dpp v58, v52, v37 row_newbcast:5 row_mask:0xf bank_mask:0xf
    v_fmac_f32_dpp v59, v52, v45 row_newbcast:5 row_mask:0xf bank_mask:0xf
    v_fmac_f32_dpp v48, v52, v34 row_newbcast:2 row_mask:0xf bank_mask:0xf
    v_fmac_f32_dpp v49, v52, v42 row_newbcast:2 row_mask:0xf bank_mask:0xf
    v_fmac_f32_dpp v58, v52, v38 row_newbcast:6 row_mask:0xf bank_mask:0xf
    v_fmac_f32_dpp v59, v52, v46 row_newbcast:6 row_mask:0xf bank_mask:0xf
    v_fmac_f32_dpp v48, v52, v35 row_newbcast:3 row_mask:0xf bank_mask:0xf
    v_fmac_f32_dpp v49, v52, v43 row_newbcast:3 row_mask:0xf bank_mask:0xf
    v_fmac_f32_dpp v58, v52, v39 row_newbcast:7 row_mask:0xf bank_mask:0xf
    v_fmac_f32_dpp v59, v52, v47 row_newbcast:7 row_mask:0xf bank_mask:0xf
    v_pk_add_f32 v[48:49], v[48:49], v[58:59]
    v_cmp_u_f32 vcc, v48, v49
    s_cbranch_vccnz L_w_retry
L_w_ok:
    ds_write2_b32 v24, v48, v49 offset0:0 offset1:16
    s_cmp_ge_u32 s3, 1
    s_waitcnt lgkmcnt(0)
    s_barrier
    s_cbranch_scc1 L_done
    ds_read_b128 v[32:35], v25 offset:0
    ds_read_b128 v[36:39], v25 offset:512
    ds_read_b128 v[40:43], v25 offset:1024
    ds_read_b128 v[44:47], v25 offset:1536
    s_waitcnt lgkmcnt(2)
    v_pk_add_f32 v[32:33], v[32:33], v[36:37]
    v_pk_add_f32 v[34:35], v[34:35], v[38:39]
    s_waitcnt lgkmcnt(0)
    v_pk_add_f32 v[40:41], v[40:41], v[44:45]
    v_pk_add_f32 v[42:43], v[42:43], v[46:47]
    v_pk_add_f32 v[32:33], v[32:33], v[40:41]
    v_pk_add_f32 v[34:35], v[34:35], v[42:43]
    v_cvt_pk_bf16_f32 v32, v32, v33
    v_cvt_pk_bf16_f32 v33, v34, v35
    buffer_store_dwordx2 v[32:33], v26, s[36:39], s56 offen sc1
L_done:
    s_endpgm
.p2align 12
L_su_w:
    s_mov_b32 s96, 0
    s_mov_b64 s[48:49], s[16:17]
    s_mov_b32 s50, 4194304
    s_mov_b32 s51, s43
    s_movk_i32 s78, 1024
    s_lshl_b32 s79, s4, 13
    s_add_u32 s79, s79, s5
    s_lshl_b32 s79, s79, 6
    s_and_b32 s77, s4, 6
    s_add_u32 s77, s77, s4
    s_lshl4_add_u32 s56, s77, s5
    s_lshl_b32 s56, s56, 8
    s_lshl_b32 s65, s4, 8
    s_add_u32 s65, s65, s3
    s_lshl_b32 s65, s65, 8
    s_add_u32 s65, s65, 1085440
    s_lshl3_add_u32 s66, s4, s3
    s_lshl_b32 s66, s66, 13
    s_add_u32 s66, s66, 1048576
    s_add_u32 s67, s66, 4096
    v_and_b32 v1, 7, v0
    v_lshlrev_b32 v1, 3, v1
    v_lshl_add_u32 v21, v3, 6, v1
    v_lshlrev_b32 v22, 6, v10
    v_lshl_add_u32 v22, v12, 5, v22
    v_lshl_add_u32 v22, v4, 3, v22
    s_lshl1_add_u32 s77, s98, 65536
    v_add_u32 v22, s77, v22
    v_xor_b32 v23, 32, v22
    v_lshlrev_b32 v24, 2, v7
    v_lshl_add_u32 v24, v3, 7, v24
    s_lshl_b32 s77, s3, 9
    s_add_u32 s77, s77, 142336
    v_add_u32 v24, s77, v24
    v_and_b32 v25, 0x1f0, v8
    v_lshrrev_b32 v26, 1, v25
    v_add_u32 v25, 142336, v25
    v_lshrrev_b32 v1, 5, v0
    v_lshl_add_u32 v26, v1, 13, v26
    s_mul_i32 s77, s3, 163840
    s_add_u32 s56, s56, s77
    s_branch L_su_done
L_w_retry:
    buffer_load_dwordx2 v[50:51], v21, s[36:39], s65 offen sc1
    v_pk_add_f32 v[54:55], v[32:33], v[34:35]
    v_pk_add_f32 v[56:57], v[36:37], v[38:39]
    v_cmp_u_f32 s[10:11], v54, v55
    v_cmp_u_f32 s[14:15], v56, v57
    s_cmp_eq_u64 s[10:11], 0
    s_cbranch_scc1 L_w_sk0
    buffer_load_dwordx4 v[64:67], v8, s[36:39], s66 offen offset:0 sc1
    buffer_load_dwordx4 v[72:75], v8, s[36:39], s66 offen offset:2048 sc1
    buffer_load_dwordx4 v[80:83], v8, s[36:39], s67 offen offset:0 sc1
    buffer_load_dwordx4 v[88:91], v8, s[36:39], s67 offen offset:2048 sc1
L_w_sk0:
    s_cmp_eq_u64 s[14:15], 0
    s_cbranch_scc1 L_w_sk1
    buffer_load_dwordx4 v[68:71], v8, s[36:39], s66 offen offset:1024 sc1
    buffer_load_dwordx4 v[76:79], v8, s[36:39], s66 offen offset:3072 sc1
    buffer_load_dwordx4 v[84:87], v8, s[36:39], s67 offen offset:1024 sc1
    buffer_load_dwordx4 v[92:95], v8, s[36:39], s67 offen offset:3072 sc1
L_w_sk1:
    s_waitcnt vmcnt(4)
    v_max_f32_dpp v52, v50, v50 quad_perm:[1,0,3,2] row_mask:0xf bank_mask:0xf
    s_nop 1
    v_max_f32_dpp v52, v52, v52 quad_perm:[2,3,0,1] row_mask:0xf bank_mask:0xf
    s_nop 1
    v_max_f32_dpp v52, v52, v52 row_ror:4 row_mask:0xf bank_mask:0xf
    v_sub_f32 v52, v50, v52
    v_mul_f32 v52, 0x3fb8aa3b, v52
    v_exp_f32 v52, v52
    s_nop 0
    v_mul_f32 v53, v52, v51
    s_nop 1
    v_add_f32_dpp v53, v53, v53 quad_perm:[1,0,3,2] row_mask:0xf bank_mask:0xf
    s_nop 1
    v_add_f32_dpp v53, v53, v53 quad_perm:[2,3,0,1] row_mask:0xf bank_mask:0xf
    s_nop 1
    v_add_f32_dpp v53, v53, v53 row_ror:4 row_mask:0xf bank_mask:0xf
    v_rcp_f32 v53, v53
    s_nop 0
    v_mul_f32 v52, v52, v53
    s_waitcnt vmcnt(0)
    s_cmp_eq_u64 s[10:11], 0
    s_cbranch_scc1 L_w_sm0
    v_mfma_f32_16x16x32_bf16 v[32:35], v[64:67], v[96:99], 0
    v_mfma_f32_16x16x32_bf16 v[40:43], v[64:67], v[112:115], 0
    v_mfma_f32_16x16x32_bf16 v[32:35], v[72:75], v[100:103], v[32:35]
    v_mfma_f32_16x16x32_bf16 v[40:43], v[72:75], v[116:119], v[40:43]
    v_mfma_f32_16x16x32_bf16 v[32:35], v[80:83], v[104:107], v[32:35]
    v_mfma_f32_16x16x32_bf16 v[40:43], v[80:83], v[120:123], v[40:43]
    v_mfma_f32_16x16x32_bf16 v[32:35], v[88:91], v[108:111], v[32:35]
    v_mfma_f32_16x16x32_bf16 v[40:43], v[88:91], v[124:127], v[40:43]
L_w_sm0:
    s_cmp_eq_u64 s[14:15], 0
    s_cbranch_scc1 L_w_sm1
    v_mfma_f32_16x16x32_bf16 v[36:39], v[68:71], v[96:99], 0
    v_mfma_f32_16x16x32_bf16 v[44:47], v[68:71], v[112:115], 0
    v_mfma_f32_16x16x32_bf16 v[36:39], v[76:79], v[100:103], v[36:39]
    v_mfma_f32_16x16x32_bf16 v[44:47], v[76:79], v[116:119], v[44:47]
    v_mfma_f32_16x16x32_bf16 v[36:39], v[84:87], v[104:107], v[36:39]
    v_mfma_f32_16x16x32_bf16 v[44:47], v[84:87], v[120:123], v[44:47]
    v_mfma_f32_16x16x32_bf16 v[36:39], v[92:95], v[108:111], v[36:39]
    v_mfma_f32_16x16x32_bf16 v[44:47], v[92:95], v[124:127], v[44:47]
L_w_sm1:
    s_nop 4
    v_mul_f32_dpp v48, v52, v32 row_newbcast:0 row_mask:0xf bank_mask:0xf
    v_mul_f32_dpp v49, v52, v40 row_newbcast:0 row_mask:0xf bank_mask:0xf
    v_mul_f32_dpp v58, v52, v36 row_newbcast:4 row_mask:0xf bank_mask:0xf
    v_mul_f32_dpp v59, v52, v44 row_newbcast:4 row_mask:0xf bank_mask:0xf
    v_fmac_f32_dpp v48, v52, v33 row_newbcast:1 row_mask:0xf bank_mask:0xf
    v_fmac_f32_dpp v49, v52, v41 row_newbcast:1 row_mask:0xf bank_mask:0xf
    v_fmac_f32_dpp v58, v52, v37 row_newbcast:5 row_mask:0xf bank_mask:0xf
    v_fmac_f32_dpp v59, v52, v45 row_newbcast:5 row_mask:0xf bank_mask:0xf
    v_fmac_f32_dpp v48, v52, v34 row_newbcast:2 row_mask:0xf bank_mask:0xf
    v_fmac_f32_dpp v49, v52, v42 row_newbcast:2 row_mask:0xf bank_mask:0xf
    v_fmac_f32_dpp v58, v52, v38 row_newbcast:6 row_mask:0xf bank_mask:0xf
    v_fmac_f32_dpp v59, v52, v46 row_newbcast:6 row_mask:0xf bank_mask:0xf
    v_fmac_f32_dpp v48, v52, v35 row_newbcast:3 row_mask:0xf bank_mask:0xf
    v_fmac_f32_dpp v49, v52, v43 row_newbcast:3 row_mask:0xf bank_mask:0xf
    v_fmac_f32_dpp v58, v52, v39 row_newbcast:7 row_mask:0xf bank_mask:0xf
    v_fmac_f32_dpp v59, v52, v47 row_newbcast:7 row_mask:0xf bank_mask:0xf
    v_pk_add_f32 v[48:49], v[48:49], v[58:59]
    v_cmp_u_f32 vcc, v48, v49
    s_cbranch_vccz L_w_ok
    s_add_u32 s78, s78, 1
    s_cmp_lt_u32 s78, 65536
    s_cbranch_scc1 L_w_retry
    s_branch L_w_ok
L_su_g:
    s_mov_b32 s96, 1
    s_mov_b64 s[48:49], s[20:21]
    s_mov_b32 s50, 1835008
    s_mov_b32 s51, s43
    s_mov_b64 s[52:53], s[22:23]
    s_mov_b32 s54, 1835008
    s_mov_b32 s55, s43
    s_cmp_eq_u32 s4, 7
    s_cselect_b32 s50, 0, s50
    s_movk_i32 s78, 3584
    s_lshl3_add_u32 s77, s4, s7
    s_lshl_b32 s79, s77, 6
    s_mul_i32 s56, s77, 4682
    s_lshr_b32 s56, s56, 16
    s_and_b32 s57, s56, 2
    s_lshl4_add_u32 s57, s57, s77
    s_lshl1_add_u32 s56, s56, s57
    s_lshl_b32 s56, s56, 8
    s_add_u32 s56, s56, 65536
    v_lshrrev_b32 v1, 2, v7
    v_lshrrev_b32 v21, 1, v3
    v_cmp_eq_u32 vcc, v1, v3
    v_and_b32 v1, 1, v0
    v_lshlrev_b32 v1, 4, v1
    v_mov_b32 v22, 0x3f80
    v_lshlrev_b32 v1, v1, v22
    v_cndmask_b32 v1, 0, v1, vcc
    v_bfe_u32 v22, v0, 1, 1
    v_cmp_eq_u32 vcc, 0, v22
    s_nop 1
    v_cndmask_b32 v244, 0, v1, vcc
    v_cmp_eq_u32 vcc, 1, v22
    s_nop 1
    v_cndmask_b32 v245, 0, v1, vcc
    v_mov_b32 v242, 0
    v_mov_b32 v243, 0
    v_mov_b32 v246, 0
    v_mov_b32 v247, 0
    v_lshlrev_b32 v26, 4, v4
    v_lshl_add_u32 v26, v12, 3, v26
    v_lshl_add_u32 v26, v21, 2, v26
    v_lshl_add_u32 v26, s3, 6, v26
    v_lshlrev_b32 v31, 2, v0
    v_lshrrev_b32 v1, 3, v0
    v_lshlrev_b32 v25, 8, v1
    v_and_b32 v29, 1, v10
    v_lshlrev_b32 v28, 10, v29
    v_lshl_add_u32 v27, v1, 6, v28
    v_lshl_add_u32 v27, v4, 4, v27
    s_and_b32 s77, s3, 1
    s_and_b32 s58, s3, 2
    s_lshl_b32 s64, s58, 10
    s_lshl_b32 s66, s77, 9
    s_add_u32 s66, s66, s64
    s_lshl_b32 s59, s77, 11
    v_add_u32 v29, s58, v29
    v_lshlrev_b32 v29, 4, v29
    v_and_b32 v22, 1, v0
    v_lshl_add_u32 v22, v22, 7, v25
    v_add3_u32 v22, v22, v29, s59
    v_lshl_add_u32 v29, s77, 3, v29
    s_lshl_b32 s58, s58, 6
    s_add_u32 s59, s59, s58
    v_and_b32 v21, 0x70, v8
    v_add_u32 v21, v21, v25
    v_add_u32 v25, 4096, v21
    v_lshlrev_b32 v30, 4, v4
    v_lshl_add_u32 v23, v3, 6, v30
    s_mov_b32 exec_lo, 0xf000f0
    s_mov_b32 exec_hi, 0xf000f0
    v_add_u32 v23, 8320, v23
    s_mov_b32 exec_lo, 0xf000f00
    s_mov_b32 exec_hi, 0xf000f00
    v_add_u32 v23, 4096, v23
    s_mov_b64 exec, -1
    v_bfe_u32 v1, v0, 1, 1
    v_lshl_add_u32 v22, v1, 3, v22
    v_lshlrev_b32 v24, 6, v10
    v_lshl_add_u32 v24, v1, 15, v24
    v_lshl_add_u32 v1, v12, 1, v1
    v_xor_b32 v1, s3, v1
    v_lshl_add_u32 v24, v1, 4, v24
    v_and_b32 v1, 1, v0
    v_lshl_add_u32 v24, v1, 3, v24
    v_add_u32 v24, 65536, v24
    s_branch L_su_done
L_role_g:
    s_cmp_eq_u32 s4, 7
    s_cbranch_scc1 L_done
    v_and_b32 v63, 7, v0
    v_lshlrev_b32 v63, 7, v63
    s_mov_b32 s9, 679936
    buffer_load_dword v62, v63, s[36:39], s9 offen sc1
    s_add_u32 m0, s80, 32768
    s_nop 0
    buffer_load_dwordx4 v11, s[52:55], s79 offen offset:0 lds
    s_add_u32 s97, s79, s74
    buffer_load_dwordx4 v11, s[52:55], s97 offen offset:1024 lds
    s_add_u32 s97, s97, s74
    buffer_load_dwordx4 v11, s[52:55], s97 offen offset:2048 lds
    s_add_u32 s97, s97, s74
    buffer_load_dwordx4 v11, s[52:55], s97 offen offset:3072 lds
    s_barrier
    s_add_u32 m0, s8, 0
    s_nop 0
    buffer_load_dwordx4 v10, s[48:51], s75 offen offset:0 lds
    s_add_u32 s97, s75, s74
    buffer_load_dwordx4 v10, s[48:51], s97 offen offset:1024 lds
    s_add_u32 s97, s97, s74
    buffer_load_dwordx4 v10, s[48:51], s97 offen offset:2048 lds
    s_add_u32 s97, s97, s74
    buffer_load_dwordx4 v10, s[48:51], s97 offen offset:3072 lds
    s_add_u32 m0, s8, 32768
    s_nop 0
    buffer_load_dwordx4 v11, s[52:55], s75 offen offset:0 lds
    s_add_u32 s97, s75, s74
    buffer_load_dwordx4 v11, s[52:55], s97 offen offset:1024 lds
    s_add_u32 s97, s97, s74
    buffer_load_dwordx4 v11, s[52:55], s97 offen offset:2048 lds
    s_add_u32 s97, s97, s74
    buffer_load_dwordx4 v11, s[52:55], s97 offen offset:3072 lds
    buffer_load_dwordx4 v[40:43], v27, s[60:63], s66 offen
    buffer_load_ushort v56, v28, s[60:63], s64 offen
    v_readfirstlane_b32 s78, v61
    s_getreg_b32 s72, hwreg(HW_REG_XCC_ID, 2, 1)
    s_mov_b32 s77, 0
    s_waitcnt vmcnt(0)
L_gr_chk_g:
    v_xor_b32 v1, s78, v62
    v_cmp_lt_u32 vcc, 1, v1
    s_cbranch_vccz L_gr_ok_g
    buffer_load_dword v62, v63, s[36:39], s9 offen sc1
    s_waitcnt vmcnt(0)
    s_add_u32 s77, s77, 1
    s_cmp_lt_u32 s77, 65536
    s_cbranch_scc1 L_gr_chk_g
L_gr_ok_g:
    v_cmp_eq_u32 vcc, 1, v1
    s_nop 0
    s_bcnt1_i32_b32 s78, vcc_lo
    s_cmp_gt_u32 s78, 16
    s_cselect_b32 s78, 1, 0
    s_xor_b32 s72, s72, s78
    s_and_b32 s72, s72, 1
    s_lshl_b32 s72, s72, 13
    s_add_u32 s56, s56, s72
    s_xor_b32 s57, s56, 8192
    s_cmp_eq_u32 s3, 0
    s_cselect_b32 s56, s57, s56
    s_add_u32 s77, s59, s72
    s_add_u32 s65, s77, 131072
    s_add_u32 s67, s65, 16384
    s_add_u32 s68, s77, 0
    s_add_u32 s69, s77, 16384
    s_add_u32 s70, s77, 32768
    s_add_u32 s71, s77, 49152
    s_mov_b32 s79, 0
    s_barrier
    buffer_load_dwordx4 v[44:47], v21, s[36:39], s65 offen sc1
    buffer_load_dwordx4 v[48:51], v25, s[36:39], s65 offen sc1
    buffer_load_dwordx4 v[52:55], v21, s[36:39], s67 offen sc1
    ds_read_b64_tr_b16 v[128:129], v24 offset:0
    ds_read_b64_tr_b16 v[130:131], v24 offset:1024
    ds_read_b64_tr_b16 v[132:133], v24 offset:2048
    ds_read_b64_tr_b16 v[134:135], v24 offset:3072
    ds_read_b64_tr_b16 v[136:137], v24 offset:4096
    ds_read_b64_tr_b16 v[138:139], v24 offset:5120
    ds_read_b64_tr_b16 v[140:141], v24 offset:6144
    ds_read_b64_tr_b16 v[142:143], v24 offset:7168
    s_waitcnt lgkmcnt(4)
    ds_read_b64_tr_b16 v[144:145], v24 offset:8192
    ds_read_b64_tr_b16 v[146:147], v24 offset:9216
    ds_read_b64_tr_b16 v[148:149], v24 offset:10240
    ds_read_b64_tr_b16 v[150:151], v24 offset:11264
    ds_read_b64_tr_b16 v[152:153], v24 offset:12288
    ds_read_b64_tr_b16 v[154:155], v24 offset:13312
    ds_read_b64_tr_b16 v[156:157], v24 offset:14336
    ds_read_b64_tr_b16 v[158:159], v24 offset:15360
    s_waitcnt lgkmcnt(4)
    ds_read_b64_tr_b16 v[160:161], v24 offset:16384
    ds_read_b64_tr_b16 v[162:163], v24 offset:17408
    ds_read_b64_tr_b16 v[164:165], v24 offset:18432
    ds_read_b64_tr_b16 v[166:167], v24 offset:19456
    ds_read_b64_tr_b16 v[168:169], v24 offset:20480
    ds_read_b64_tr_b16 v[170:171], v24 offset:21504
    ds_read_b64_tr_b16 v[172:173], v24 offset:22528
    ds_read_b64_tr_b16 v[174:175], v24 offset:23552
    s_waitcnt lgkmcnt(4)
    ds_read_b64_tr_b16 v[176:177], v24 offset:24576
    ds_read_b64_tr_b16 v[178:179], v24 offset:25600
    ds_read_b64_tr_b16 v[180:181], v24 offset:26624
    ds_read_b64_tr_b16 v[182:183], v24 offset:27648
    ds_read_b64_tr_b16 v[184:185], v24 offset:28672
    ds_read_b64_tr_b16 v[186:187], v24 offset:29696
    ds_read_b64_tr_b16 v[188:189], v24 offset:30720
    ds_read_b64_tr_b16 v[190:191], v24 offset:31744
    s_waitcnt lgkmcnt(4)
    v_lshlrev_b32 v192, 16, v40
    v_and_b32 v193, s83, v40
    v_lshlrev_b32 v194, 16, v41
    v_and_b32 v195, s83, v41
    v_lshlrev_b32 v196, 16, v42
    v_and_b32 v197, s83, v42
    v_lshlrev_b32 v198, 16, v43
    v_and_b32 v199, s83, v43
    v_lshlrev_b32 v56, 16, v56
    v_pk_add_f32 v[192:193], v[192:193], v[56:57] op_sel_hi:[1,0] neg_lo:[0,1] neg_hi:[0,1]
    v_pk_add_f32 v[194:195], v[194:195], v[56:57] op_sel_hi:[1,0] neg_lo:[0,1] neg_hi:[0,1]
    v_pk_add_f32 v[196:197], v[196:197], v[56:57] op_sel_hi:[1,0] neg_lo:[0,1] neg_hi:[0,1]
    v_pk_add_f32 v[198:199], v[198:199], v[56:57] op_sel_hi:[1,0] neg_lo:[0,1] neg_hi:[0,1]
    s_branch L_g_m_in
L_g_m_retry:
    buffer_load_dwordx4 v[44:47], v21, s[36:39], s65 offen sc1
    buffer_load_dwordx4 v[48:51], v25, s[36:39], s65 offen sc1
    buffer_load_dwordx4 v[52:55], v21, s[36:39], s67 offen sc1
L_g_m_in:
    s_waitcnt vmcnt(0)
    v_max3_u32 v1, v44, v45, v46
    v_max3_u32 v1, v1, v47, v48
    v_max3_u32 v1, v1, v49, v50
    v_max3_u32 v1, v1, v51, v52
    v_max3_u32 v1, v1, v53, v54
    v_max_u32 v1, v1, v55
    v_cmp_eq_u32 vcc, -1, v1
    s_cbranch_vccz L_g_m_ok
    s_add_u32 s79, s79, 1
    s_cmp_lt_u32 s79, 65536
    s_cbranch_scc1 L_g_m_retry
L_g_m_ok:
    buffer_load_dwordx4 v[64:67], v21, s[36:39], s68 offen sc1
    buffer_load_dwordx4 v[68:71], v25, s[36:39], s68 offen sc1
    buffer_load_dwordx4 v[72:75], v21, s[36:39], s69 offen sc1
    buffer_load_dwordx4 v[76:79], v25, s[36:39], s69 offen sc1
    buffer_load_dwordx4 v[80:83], v21, s[36:39], s70 offen sc1
    buffer_load_dwordx4 v[84:87], v25, s[36:39], s70 offen sc1
    buffer_load_dwordx4 v[88:91], v21, s[36:39], s71 offen sc1
    buffer_load_dwordx4 v[92:95], v25, s[36:39], s71 offen sc1
    s_mov_b32 s79, 0
    ds_write_b64 v22, v[48:49] offset:4096
    ds_write_b64 v22, v[50:51] offset:4160
    v_lshlrev_b32 v216, 16, v52
    v_and_b32 v217, s83, v52
    v_lshlrev_b32 v218, 16, v53
    v_and_b32 v219, s83, v53
    v_lshlrev_b32 v220, 16, v54
    v_and_b32 v221, s83, v54
    v_lshlrev_b32 v222, 16, v55
    v_and_b32 v223, s83, v55
    v_pk_add_f32 v[216:217], v[216:217], 1.0 op_sel_hi:[1,0]
    v_pk_add_f32 v[218:219], v[218:219], 1.0 op_sel_hi:[1,0]
    v_pk_add_f32 v[220:221], v[220:221], 1.0 op_sel_hi:[1,0]
    v_pk_add_f32 v[222:223], v[222:223], 1.0 op_sel_hi:[1,0]
    v_cvt_pk_bf16_f32 v52, v216, v217
    v_cvt_pk_bf16_f32 v53, v218, v219
    v_cvt_pk_bf16_f32 v54, v220, v221
    v_cvt_pk_bf16_f32 v55, v222, v223
    v_lshlrev_b32 v216, 16, v52
    v_and_b32 v217, s83, v52
    v_lshlrev_b32 v218, 16, v53
    v_and_b32 v219, s83, v53
    v_lshlrev_b32 v220, 16, v54
    v_and_b32 v221, s83, v54
    v_lshlrev_b32 v222, 16, v55
    v_and_b32 v223, s83, v55
    ds_write_b64 v22, v[52:53] offset:8320
    ds_write_b64 v22, v[54:55] offset:8384
    v_lshlrev_b32 v200, 16, v44
    v_and_b32 v201, s83, v44
    v_lshlrev_b32 v202, 16, v45
    v_and_b32 v203, s83, v45
    v_lshlrev_b32 v204, 16, v46
    v_and_b32 v205, s83, v46
    v_lshlrev_b32 v206, 16, v47
    v_and_b32 v207, s83, v47
    v_pk_mul_f32 v[208:209], v[200:201], v[216:217]
    v_pk_mul_f32 v[210:211], v[202:203], v[218:219]
    v_pk_mul_f32 v[212:213], v[204:205], v[220:221]
    v_pk_mul_f32 v[214:215], v[206:207], v[222:223]
    v_pk_mul_f32 v[216:217], v[192:193], v[216:217]
    v_pk_mul_f32 v[218:219], v[194:195], v[218:219]
    v_pk_mul_f32 v[220:221], v[196:197], v[220:221]
    v_pk_mul_f32 v[222:223], v[198:199], v[222:223]
    s_branch L_g_in
L_g_retry:
    buffer_load_dwordx4 v[64:67], v21, s[36:39], s68 offen sc1
    buffer_load_dwordx4 v[68:71], v25, s[36:39], s68 offen sc1
    buffer_load_dwordx4 v[72:75], v21, s[36:39], s69 offen sc1
    buffer_load_dwordx4 v[76:79], v25, s[36:39], s69 offen sc1
    buffer_load_dwordx4 v[80:83], v21, s[36:39], s70 offen sc1
    buffer_load_dwordx4 v[84:87], v25, s[36:39], s70 offen sc1
    buffer_load_dwordx4 v[88:91], v21, s[36:39], s71 offen sc1
    buffer_load_dwordx4 v[92:95], v25, s[36:39], s71 offen sc1
L_g_in:
    s_waitcnt vmcnt(7)
    v_mfma_f32_16x16x32_bf16 v[32:35], v[244:247], v[64:67], 0
    v_mfma_f32_16x16x32_bf16 v[36:39], v[242:245], v[64:67], 0
    s_waitcnt vmcnt(6)
    v_mfma_f32_16x16x32_bf16 v[32:35], v[244:247], v[68:71], v[32:35]
    v_mfma_f32_16x16x32_bf16 v[36:39], v[242:245], v[68:71], v[36:39]
    s_waitcnt vmcnt(5)
    v_mfma_f32_16x16x32_bf16 v[32:35], v[244:247], v[72:75], v[32:35]
    v_mfma_f32_16x16x32_bf16 v[36:39], v[242:245], v[72:75], v[36:39]
    s_waitcnt vmcnt(4)
    v_mfma_f32_16x16x32_bf16 v[32:35], v[244:247], v[76:79], v[32:35]
    v_mfma_f32_16x16x32_bf16 v[36:39], v[242:245], v[76:79], v[36:39]
    s_waitcnt vmcnt(3)
    v_mfma_f32_16x16x32_bf16 v[32:35], v[244:247], v[80:83], v[32:35]
    v_mfma_f32_16x16x32_bf16 v[36:39], v[242:245], v[80:83], v[36:39]
    s_waitcnt vmcnt(2)
    v_mfma_f32_16x16x32_bf16 v[32:35], v[244:247], v[84:87], v[32:35]
    v_mfma_f32_16x16x32_bf16 v[36:39], v[242:245], v[84:87], v[36:39]
    s_waitcnt vmcnt(1)
    v_mfma_f32_16x16x32_bf16 v[32:35], v[244:247], v[88:91], v[32:35]
    v_mfma_f32_16x16x32_bf16 v[36:39], v[242:245], v[88:91], v[36:39]
    s_waitcnt vmcnt(0)
    v_mfma_f32_16x16x32_bf16 v[32:35], v[244:247], v[92:95], v[32:35]
    v_mfma_f32_16x16x32_bf16 v[36:39], v[242:245], v[92:95], v[36:39]
    s_nop 6
    v_cmp_u_f32 vcc, v32, v32
    v_pk_fma_f32 v[40:41], v[32:33], v[208:209], v[216:217]
    v_pk_fma_f32 v[42:43], v[34:35], v[210:211], v[218:219]
    v_pk_fma_f32 v[44:45], v[36:37], v[212:213], v[220:221]
    v_pk_fma_f32 v[46:47], v[38:39], v[214:215], v[222:223]
    s_cbranch_vccnz L_g_again
L_g_ok:
    v_cvt_pk_bf16_f32 v48, v40, v41
    v_cvt_pk_bf16_f32 v49, v42, v43
    v_cvt_pk_bf16_f32 v50, v44, v45
    v_cvt_pk_bf16_f32 v51, v46, v47
    ds_write_b64 v22, v[48:49] offset:0
    ds_write_b64 v22, v[50:51] offset:64
    v_pk_fma_f32 v[32:33], v[32:33], v[200:201], v[192:193]
    v_pk_fma_f32 v[34:35], v[34:35], v[202:203], v[194:195]
    v_pk_fma_f32 v[36:37], v[36:37], v[204:205], v[196:197]
    v_pk_fma_f32 v[38:39], v[38:39], v[206:207], v[198:199]
    v_pk_add_f32 v[40:41], v[32:33], v[34:35]
    v_pk_mul_f32 v[42:43], v[32:33], v[32:33]
    v_pk_add_f32 v[44:45], v[36:37], v[38:39]
    v_pk_fma_f32 v[42:43], v[34:35], v[34:35], v[42:43]
    v_pk_add_f32 v[40:41], v[40:41], v[44:45]
    v_pk_fma_f32 v[42:43], v[36:37], v[36:37], v[42:43]
    s_waitcnt lgkmcnt(0)
    s_barrier
    ds_read_b128 v[64:67], v23 offset:0
    ds_read_b128 v[68:71], v23 offset:256
    ds_read_b128 v[72:75], v23 offset:512
    ds_read_b128 v[76:79], v23 offset:768
    ds_read_b128 v[80:83], v23 offset:1024
    ds_read_b128 v[84:87], v23 offset:1280
    ds_read_b128 v[88:91], v23 offset:1536
    ds_read_b128 v[92:95], v23 offset:1792
    ds_read_b128 v[96:99], v23 offset:2048
    ds_read_b128 v[100:103], v23 offset:2304
    ds_read_b128 v[104:107], v23 offset:2560
    ds_read_b128 v[108:111], v23 offset:2816
    v_add_f32 v40, v40, v41
    v_pk_fma_f32 v[42:43], v[38:39], v[38:39], v[42:43]
    v_add_f32 v41, v42, v43
    v_add_f32_dpp v40, v40, v40 quad_perm:[1,0,3,2] row_mask:0xf bank_mask:0xf
    s_nop 0
    v_add_f32_dpp v41, v41, v41 quad_perm:[1,0,3,2] row_mask:0xf bank_mask:0xf
    v_add_f32_dpp v40, v40, v40 quad_perm:[2,3,0,1] row_mask:0xf bank_mask:0xf
    s_nop 0
    v_add_f32_dpp v41, v41, v41 quad_perm:[2,3,0,1] row_mask:0xf bank_mask:0xf
    v_add_f32_dpp v40, v40, v40 row_ror:8 row_mask:0xf bank_mask:0xf
    s_nop 0
    v_add_f32_dpp v41, v41, v41 row_ror:8 row_mask:0xf bank_mask:0xf
    s_waitcnt lgkmcnt(11)
    v_mfma_f32_16x16x32_bf16 v[32:35], v[128:131], v[64:67], 0
    ds_read_b128 v[112:115], v23 offset:3072
    v_mov_b32 v42, v40
    v_mov_b32 v43, v41
    s_waitcnt lgkmcnt(11)
    v_mfma_f32_16x16x32_bf16 v[32:35], v[132:135], v[68:71], v[32:35]
    ds_read_b128 v[116:119], v23 offset:3328
    v_permlane16_swap_b32 v40, v42
    v_permlane16_swap_b32 v41, v43
    s_waitcnt lgkmcnt(11)
    v_mfma_f32_16x16x32_bf16 v[32:35], v[136:139], v[72:75], v[32:35]
    ds_read_b128 v[120:123], v23 offset:3584
    v_pk_add_f32 v[40:41], v[40:41], v[42:43]
    s_waitcnt lgkmcnt(11)
    v_mfma_f32_16x16x32_bf16 v[32:35], v[140:143], v[76:79], v[32:35]
    ds_read_b128 v[124:127], v23 offset:3840
    v_mov_b32 v42, v40
    v_mov_b32 v43, v41
    s_waitcnt lgkmcnt(11)
    v_mfma_f32_16x16x32_bf16 v[32:35], v[144:147], v[80:83], v[32:35]
    v_permlane32_swap_b32 v40, v42
    v_permlane32_swap_b32 v41, v43
    s_waitcnt lgkmcnt(10)
    v_mfma_f32_16x16x32_bf16 v[32:35], v[148:151], v[84:87], v[32:35]
    v_pk_add_f32 v[40:41], v[40:41], v[42:43]
    s_waitcnt lgkmcnt(9)
    v_mfma_f32_16x16x32_bf16 v[32:35], v[152:155], v[88:91], v[32:35]
    ds_write_b64 v29, v[40:41] offset:16384
    s_waitcnt lgkmcnt(9)
    v_mfma_f32_16x16x32_bf16 v[32:35], v[156:159], v[92:95], v[32:35]
    s_waitcnt lgkmcnt(8)
    v_mfma_f32_16x16x32_bf16 v[32:35], v[160:163], v[96:99], v[32:35]
    s_waitcnt lgkmcnt(7)
    v_mfma_f32_16x16x32_bf16 v[32:35], v[164:167], v[100:103], v[32:35]
    s_waitcnt lgkmcnt(0)
    s_barrier
    ds_read_b128 v[40:43], v30 offset:16384
    s_waitcnt lgkmcnt(7)
    v_mfma_f32_16x16x32_bf16 v[32:35], v[168:171], v[104:107], v[32:35]
    s_waitcnt lgkmcnt(6)
    v_mfma_f32_16x16x32_bf16 v[32:35], v[172:175], v[108:111], v[32:35]
    s_waitcnt lgkmcnt(5)
    v_mfma_f32_16x16x32_bf16 v[32:35], v[176:179], v[112:115], v[32:35]
    s_waitcnt lgkmcnt(4)
    v_mfma_f32_16x16x32_bf16 v[32:35], v[180:183], v[116:119], v[32:35]
    s_waitcnt lgkmcnt(3)
    v_mfma_f32_16x16x32_bf16 v[32:35], v[184:187], v[120:123], v[32:35]
    s_waitcnt lgkmcnt(2)
    v_mfma_f32_16x16x32_bf16 v[32:35], v[188:191], v[124:127], v[32:35]
    s_waitcnt lgkmcnt(0)
    v_pk_add_f32 v[40:41], v[40:41], v[42:43]
    v_mul_f32 v40, 0xbb000000, v40
    v_mul_f32 v41, 0x3b000000, v41
    v_fma_f32 v41, -v40, v40, v41
    v_max_f32 v41, 0, v41
    v_add_f32 v41, 0x3727c5ac, v41
    v_rsq_f32 v42, v41
    v_mov_b32_dpp v36, v32 row_shl:8 row_mask:0xf bank_mask:0x1
    v_mov_b32_dpp v37, v33 row_shl:8 row_mask:0xf bank_mask:0x1
    v_mov_b32_dpp v38, v34 row_shl:8 row_mask:0xf bank_mask:0x1
    v_mov_b32_dpp v39, v35 row_shl:8 row_mask:0xf bank_mask:0x1
    v_fmac_f32_dpp v32, v32, v40 row_shl:4 row_mask:0xf bank_mask:0x1
    v_fmac_f32_dpp v33, v33, v40 row_shl:4 row_mask:0xf bank_mask:0x1
    v_fmac_f32_dpp v34, v34, v40 row_shl:4 row_mask:0xf bank_mask:0x1
    v_fmac_f32_dpp v35, v35, v40 row_shl:4 row_mask:0xf bank_mask:0x1
    v_pk_fma_f32 v[32:33], v[32:33], v[42:43], v[36:37] op_sel_hi:[1,0,1]
    v_pk_fma_f32 v[34:35], v[34:35], v[42:43], v[38:39] op_sel_hi:[1,0,1]
    s_nop 1
    v_permlane32_swap_b32 v32, v34
    v_permlane32_swap_b32 v33, v35
    v_mul_f32 v32, 0xbfb8aa3b, v32
    v_mul_f32 v33, 0xbfb8aa3b, v33
    v_exp_f32 v32, v32
    v_exp_f32 v33, v33
    s_mov_b32 exec_lo, 0xf000f
    s_mov_b32 exec_hi, 0xf000f
    v_pk_add_f32 v[32:33], v[32:33], 1.0 op_sel_hi:[1,0]
    v_rcp_f32 v32, v32
    v_rcp_f32 v33, v33
    s_cmp_ge_u32 s3, 2
    v_pk_mul_f32 v[32:33], v[32:33], v[34:35]
    v_cvt_pk_bf16_f32 v32, v32, v33
    ds_write_b32 v26, v32 offset:16640
    s_mov_b64 exec, -1
    s_waitcnt lgkmcnt(0)
    s_barrier
    s_cbranch_scc1 L_done
    ds_read_b32 v32, v31 offset:16640
    s_waitcnt lgkmcnt(0)
    buffer_store_dword v32, v31, s[36:39], s56 offen sc1
    s_branch L_d_epoch
L_g_again:
    s_add_u32 s79, s79, 1
    s_cmp_lt_u32 s79, 65536
    s_cbranch_scc1 L_g_retry
    s_branch L_g_ok
.p2align 12
L_su_m:
    s_mov_b32 s96, 2
    s_mov_b64 s[48:49], s[28:29]
    s_mov_b32 s50, 3145728
    s_mov_b32 s51, s43
    s_mov_b64 s[52:53], s[24:25]
    s_mov_b32 s54, 1835008
    s_mov_b32 s55, s43
    s_mov_b64 s[68:69], s[30:31]
    s_mov_b32 s70, 4096
    s_mov_b32 s71, s43
    s_movk_i32 s78, 6144
    s_lshl3_add_u32 s77, s4, s7
    s_lshl_b32 s79, s77, 6
    s_addk_i32 s79, 2048
    s_lshl_b32 s64, s77, 4
    s_and_b32 s56, s77, 32
    s_add_u32 s56, s56, s77
    s_lshl_b32 s56, s56, 8
    s_add_u32 s56, s56, 131072
    s_lshr_b32 s65, s77, 2
    s_lshl_b32 s65, s65, 8
    s_and_b32 s77, s64, 63
    s_add_u32 s65, s65, s77
    v_lshrrev_b32 v1, 2, v7
    s_lshl_b32 s77, s3, 8
    v_lshrrev_b32 v29, 3, v7
    v_lshlrev_b32 v29, 9, v29
    v_lshl_add_u32 v29, v3, 7, v29
    v_and_b32 v30, 0x70, v8
    v_add_u32 v29, v29, v30
    s_and_b32 s58, s98, 0x2000
    s_add_u32 s58, s58, s98
    s_add_u32 s58, s58, 65536
    v_lshlrev_b32 v193, 2, v4
    v_lshl_add_u32 v192, v1, 10, v193
    v_lshl_add_u32 v193, v1, 6, v193
    v_lshl_add_u32 v194, v12, 12, v193
    v_lshrrev_b32 v1, 1, v3
    v_lshl_add_u32 v194, v1, 14, v194
    v_lshlrev_b32 v30, 7, v1
    v_lshl_add_u32 v30, v4, 5, v30
    v_lshl_add_u32 v30, v12, 4, v30
    s_add_u32 s77, s77, 144384
    v_add_u32 v30, s77, v30
    v_lshlrev_b32 v31, 3, v7
    v_add_u32 v31, 144384, v31
    v_bfe_u32 v27, v0, 3, 2
    v_lshl_add_u32 v27, v27, 2, v1
    v_bfe_u32 v1, v0, 1, 2
    v_lshl_add_u32 v27, v27, 2, v1
    v_and_b32 v1, 1, v0
    v_lshl_add_u32 v27, v1, 3, v27
    v_lshlrev_b32 v27, 10, v27
    s_mul_i32 s57, s3, 7168
    s_lshl_b32 s66, s57, 6
    s_add_u32 s66, s66, s64
    s_add_u32 s57, s57, 98304
    v_lshlrev_b32 v28, 3, v0
    v_add_u32 v28, s57, v28
    v_lshlrev_b32 v22, 6, v10
    v_lshl_add_u32 v22, v12, 5, v22
    v_lshl_add_u32 v22, v4, 3, v22
    s_lshl1_add_u32 s77, s98, 65536
    v_add_u32 v22, s77, v22
    v_xor_b32 v23, 32, v22
    v_lshlrev_b32 v24, 2, v7
    v_lshl_add_u32 v24, v3, 7, v24
    s_lshl_b32 s77, s3, 9
    s_add_u32 s77, s77, 142336
    v_add_u32 v24, s77, v24
    v_and_b32 v25, 0x1f0, v8
    v_lshrrev_b32 v26, 1, v25
    v_add_u32 v25, 142336, v25
    v_lshrrev_b32 v1, 5, v0
    v_lshl_add_u32 v26, v1, 13, v26
    s_mul_i32 s77, s3, 163840
    s_add_u32 s56, s56, s77
    s_branch L_su_done
L_role_m:
    s_lshl2_add_u32 s77, s7, s3
    s_mul_i32 s77, s77, 448
    s_add_u32 s77, s77, s4
    s_lshl_b32 s77, s77, 7
    v_min_u32 v2, 55, v0
    v_lshlrev_b32 v2, 10, v2
    v_mov_b32 v231, v61
    s_waitcnt vmcnt(0) lgkmcnt(0)
    s_mov_b32 exec_lo, 0xfffffff
    s_mov_b32 exec_hi, 0x0
    buffer_load_dword v228, v2, s[52:55], s77 offen
    s_mov_b64 exec, -1
    ds_read_b64_tr_b16 v[96:97], v22 offset:0
    ds_read_b64_tr_b16 v[98:99], v22 offset:1024
    ds_read_b64_tr_b16 v[100:101], v22 offset:2048
    ds_read_b64_tr_b16 v[102:103], v22 offset:3072
    ds_read_b64_tr_b16 v[104:105], v22 offset:4096
    ds_read_b64_tr_b16 v[106:107], v22 offset:5120
    ds_read_b64_tr_b16 v[108:109], v22 offset:6144
    ds_read_b64_tr_b16 v[110:111], v22 offset:7168
    s_waitcnt lgkmcnt(4)
    ds_read_b64_tr_b16 v[112:113], v23 offset:0
    ds_read_b64_tr_b16 v[114:115], v23 offset:1024
    ds_read_b64_tr_b16 v[116:117], v23 offset:2048
    ds_read_b64_tr_b16 v[118:119], v23 offset:3072
    ds_read_b64_tr_b16 v[120:121], v23 offset:4096
    ds_read_b64_tr_b16 v[122:123], v23 offset:5120
    ds_read_b64_tr_b16 v[124:125], v23 offset:6144
    ds_read_b64_tr_b16 v[126:127], v23 offset:7168
    s_waitcnt lgkmcnt(8)
    v_mfma_f32_16x16x32_bf16 v[32:35], v[248:251], v[96:99], 0
    v_mfma_f32_16x16x32_bf16 v[36:39], v[248:251], v[100:103], 0
    v_mfma_f32_16x16x32_bf16 v[40:43], v[248:251], v[104:107], 0
    v_mfma_f32_16x16x32_bf16 v[44:47], v[248:251], v[108:111], 0
    s_waitcnt lgkmcnt(0)
    v_mfma_f32_16x16x32_bf16 v[48:51], v[248:251], v[112:115], 0
    v_mfma_f32_16x16x32_bf16 v[52:55], v[248:251], v[116:119], 0
    v_mfma_f32_16x16x32_bf16 v[56:59], v[248:251], v[120:123], 0
    v_mfma_f32_16x16x32_bf16 v[60:63], v[248:251], v[124:127], 0
    s_nop 0
    v_add_f32 v32, v32, v37
    s_nop 0
    v_add_f32 v42, v42, v47
    v_add_f32 v32, v32, v42
    s_nop 0
    v_add_f32 v48, v48, v53
    s_nop 0
    v_add_f32 v58, v58, v63
    v_add_f32 v48, v48, v58
    ds_write2_b32 v24, v32, v48 offset0:0 offset1:16
    s_cmp_ge_u32 s3, 1
    s_waitcnt lgkmcnt(0)
    s_barrier
    s_cbranch_scc1 L_m_done
    ds_read_b128 v[32:35], v25 offset:0
    ds_read_b128 v[36:39], v25 offset:512
    ds_read_b128 v[40:43], v25 offset:1024
    ds_read_b128 v[44:47], v25 offset:1536
    s_waitcnt lgkmcnt(2)
    v_pk_add_f32 v[32:33], v[32:33], v[36:37]
    v_pk_add_f32 v[34:35], v[34:35], v[38:39]
    s_waitcnt lgkmcnt(0)
    v_pk_add_f32 v[40:41], v[40:41], v[44:45]
    v_pk_add_f32 v[42:43], v[42:43], v[46:47]
    v_pk_add_f32 v[32:33], v[32:33], v[40:41]
    v_pk_add_f32 v[34:35], v[34:35], v[42:43]
    v_cvt_pk_bf16_f32 v32, v32, v33
    v_cvt_pk_bf16_f32 v33, v34, v35
    buffer_store_dwordx2 v[32:33], v26, s[36:39], s56 offen sc1
L_m_done:
    v_mov_b32 v61, v231
    s_mov_b32 m0, s57
    s_barrier
    v_and_b32 v63, 7, v0
    v_lshlrev_b32 v63, 7, v63
    s_mov_b32 s9, 679936
    buffer_load_dword v62, v63, s[36:39], s9 offen sc1
    s_mov_b32 exec_lo, 0xf0000000
    s_mov_b32 exec_hi, 0xffffff
    buffer_load_dword v228, v2, s[52:55], s77 offen
    s_mov_b64 exec, -1
    s_barrier
    buffer_load_dwordx4 v27, s[52:55], s66 offen offset:0 lds
    s_add_u32 s66, s66, 64512
    buffer_load_dwordx4 v27, s[52:55], s66 offen offset:1024 lds
    s_add_u32 s66, s66, 64512
    buffer_load_dwordx4 v27, s[52:55], s66 offen offset:2048 lds
    s_add_u32 s66, s66, 64512
    buffer_load_dwordx4 v27, s[52:55], s66 offen offset:3072 lds
    s_add_u32 s66, s66, 68608
    s_add_u32 m0, s57, 4096
    s_nop 0
    buffer_load_dwordx4 v27, s[52:55], s66 offen offset:0 lds
    s_add_u32 s66, s66, 64512
    buffer_load_dwordx4 v27, s[52:55], s66 offen offset:1024 lds
    s_add_u32 s66, s66, 64512
    buffer_load_dwordx4 v27, s[52:55], s66 offen offset:2048 lds
    v_readfirstlane_b32 s78, v61
    s_getreg_b32 s72, hwreg(HW_REG_XCC_ID, 2, 1)
    s_mov_b32 s77, 0
    s_waitcnt vmcnt(8)
L_gr_chk_d:
    v_xor_b32 v1, s78, v62
    v_cmp_lt_u32 vcc, 1, v1
    s_cbranch_vccz L_gr_ok_d
    buffer_load_dword v62, v63, s[36:39], s9 offen sc1
    s_waitcnt vmcnt(0)
    s_add_u32 s77, s77, 1
    s_cmp_lt_u32 s77, 65536
    s_cbranch_scc1 L_gr_chk_d
L_gr_ok_d:
    v_cmp_eq_u32 vcc, 1, v1
    s_nop 0
    s_bcnt1_i32_b32 s78, vcc_lo
    s_cmp_gt_u32 s78, 16
    s_cselect_b32 s78, 1, 0
    s_xor_b32 s72, s72, s78
    s_and_b32 s72, s72, 1
    s_lshl_b32 s72, s72, 13
    s_add_u32 s58, s58, s72
    s_add_u32 s59, s58, 4096
    s_add_u32 s79, s65, s72
    s_add_u32 s81, s79, 131072
    s_add_u32 s82, s81, 20480
    s_add_u32 s80, s79, 32768
    s_mov_b32 s77, 0
    s_cmp_eq_u32 s3, 0
    s_cbranch_scc1 L_d_w0
    s_waitcnt vmcnt(0)
    ds_read_b64_tr_b16 v[96:97], v28 offset:0
    ds_read_b64_tr_b16 v[98:99], v28 offset:512
    ds_read_b64_tr_b16 v[100:101], v28 offset:1024
    ds_read_b64_tr_b16 v[102:103], v28 offset:1536
    ds_read_b64_tr_b16 v[104:105], v28 offset:2048
    ds_read_b64_tr_b16 v[106:107], v28 offset:2560
    ds_read_b64_tr_b16 v[108:109], v28 offset:3072
    ds_read_b64_tr_b16 v[110:111], v28 offset:3584
    ds_read_b64_tr_b16 v[112:113], v28 offset:4096
    ds_read_b64_tr_b16 v[114:115], v28 offset:4608
    ds_read_b64_tr_b16 v[116:117], v28 offset:5120
    ds_read_b64_tr_b16 v[118:119], v28 offset:5632
    ds_read_b64_tr_b16 v[120:121], v28 offset:6144
    ds_read_b64_tr_b16 v[122:123], v28 offset:6656
    s_branch L_d_nox
L_d_w0:
    buffer_load_dword v42, v192, s[60:63], s64 offen
    buffer_load_dword v40, v193, s[36:39], s81 offen sc1
    buffer_load_dword v41, v193, s[36:39], s82 offen sc1
    buffer_load_dword v32, v194, s[36:39], s79 offen sc1
    buffer_load_dword v33, v194, s[36:39], s80 offen sc1
    s_waitcnt vmcnt(5)
    ds_read_b64_tr_b16 v[96:97], v28 offset:0
    ds_read_b64_tr_b16 v[98:99], v28 offset:512
    ds_read_b64_tr_b16 v[100:101], v28 offset:1024
    ds_read_b64_tr_b16 v[102:103], v28 offset:1536
    ds_read_b64_tr_b16 v[104:105], v28 offset:2048
    ds_read_b64_tr_b16 v[106:107], v28 offset:2560
    ds_read_b64_tr_b16 v[108:109], v28 offset:3072
    ds_read_b64_tr_b16 v[110:111], v28 offset:3584
    ds_read_b64_tr_b16 v[112:113], v28 offset:4096
    ds_read_b64_tr_b16 v[114:115], v28 offset:4608
    ds_read_b64_tr_b16 v[116:117], v28 offset:5120
    ds_read_b64_tr_b16 v[118:119], v28 offset:5632
    ds_read_b64_tr_b16 v[120:121], v28 offset:6144
    ds_read_b64_tr_b16 v[122:123], v28 offset:6656
    s_branch L_d_x_in
L_d_x_retry:
    buffer_load_dword v40, v193, s[36:39], s81 offen sc1
    buffer_load_dword v41, v193, s[36:39], s82 offen sc1
    buffer_load_dword v32, v194, s[36:39], s79 offen sc1
    buffer_load_dword v33, v194, s[36:39], s80 offen sc1
L_d_x_in:
    s_waitcnt vmcnt(0)
    v_lshlrev_b32 v48, 16, v32
    v_and_b32 v49, s83, v32
    v_lshlrev_b32 v50, 16, v33
    v_and_b32 v51, s83, v33
    v_pk_add_f32 v[48:49], v[48:49], v[50:51]
    v_mov_b32 v50, v48
    v_mov_b32 v51, v49
    s_nop 0
    v_permlane16_swap_b32 v48, v50
    v_permlane16_swap_b32 v49, v51
    v_add_f32 v48, v48, v50
    v_add_f32 v49, v49, v51
    v_mov_b32 v50, v48
    v_mov_b32 v51, v49
    s_nop 0
    v_permlane32_swap_b32 v48, v50
    v_permlane32_swap_b32 v49, v51
    v_add_f32 v48, v48, v50
    v_add_f32 v49, v49, v51
    v_lshlrev_b32 v50, 16, v40
    v_and_b32 v51, s83, v40
    v_lshlrev_b32 v52, 16, v41
    v_and_b32 v53, s83, v41
    v_lshlrev_b32 v54, 16, v42
    v_and_b32 v55, s83, v42
    v_pk_fma_f32 v[48:49], v[48:49], v[50:51], v[54:55]
    v_pk_add_f32 v[50:51], v[48:49], v[52:53]
    v_cmp_u_f32 vcc, v50, v51
    s_cbranch_vccz L_d_xok
    s_add_u32 s77, s77, 1
    s_cmp_lt_u32 s77, 65536
    s_cbranch_scc1 L_d_x_retry
L_d_xok:
L_d_nox:
    s_mov_b32 s77, 0
    s_barrier
L_d_retry:
    buffer_load_dwordx4 v[64:67], v29, s[36:39], s58 offen offset:0 sc1
    buffer_load_dwordx4 v[68:71], v29, s[36:39], s58 offen offset:1024 sc1
    buffer_load_dwordx4 v[72:75], v29, s[36:39], s58 offen offset:2048 sc1
    buffer_load_dwordx4 v[76:79], v29, s[36:39], s58 offen offset:3072 sc1
    s_waitcnt lgkmcnt(0)
    s_waitcnt vmcnt(3)
    v_mfma_f32_16x16x32_bf16 v[32:35], v[96:99], v[64:67], 0
    v_mfma_f32_16x16x32_bf16 v[36:39], v[100:103], v[64:67], 0
    s_waitcnt vmcnt(2)
    v_mfma_f32_16x16x32_bf16 v[32:35], v[104:107], v[68:71], v[32:35]
    v_mfma_f32_16x16x32_bf16 v[36:39], v[108:111], v[68:71], v[36:39]
    s_waitcnt vmcnt(1)
    v_mfma_f32_16x16x32_bf16 v[32:35], v[112:115], v[72:75], v[32:35]
    v_mfma_f32_16x16x32_bf16 v[36:39], v[116:119], v[72:75], v[36:39]
    s_waitcnt vmcnt(0)
    v_mfma_f32_16x16x32_bf16 v[32:35], v[120:123], v[76:79], v[32:35]
    s_nop 7
    v_add_f32_dpp v44, v36, v32 row_shl:8 row_mask:0xf bank_mask:0xf
    v_add_f32_dpp v45, v37, v33 row_shl:8 row_mask:0xf bank_mask:0xf
    v_add_f32_dpp v46, v38, v34 row_shl:8 row_mask:0xf bank_mask:0xf
    v_add_f32_dpp v47, v39, v35 row_shl:8 row_mask:0xf bank_mask:0xf
    v_cmp_u_f32 vcc, v44, v44
    s_nop 0
    s_and_b32 vcc_lo, vcc_lo, 0x000f000f
    s_and_b32 vcc_hi, vcc_hi, 0x00f000f0
    s_or_b32 s79, vcc_lo, vcc_hi
    s_cbranch_scc0 L_d_ok
    s_add_u32 s77, s77, 1
    s_cmp_lt_u32 s77, 65536
    s_cbranch_scc1 L_d_retry
L_d_ok:
    s_mov_b32 exec_lo, 0xf000f
    s_mov_b32 exec_hi, 0xf000f0
    ds_write_b128 v30, v[44:47]
    s_mov_b64 exec, -1
    s_cmp_lg_u32 s3, 0
    s_waitcnt lgkmcnt(0)
    s_barrier
    s_cbranch_scc1 L_done
    ds_read_b64 v[64:65], v31 offset:0
    ds_read_b64 v[66:67], v31 offset:128
    ds_read_b64 v[68:69], v31 offset:256
    ds_read_b64 v[70:71], v31 offset:384
    ds_read_b64 v[72:73], v31 offset:512
    ds_read_b64 v[74:75], v31 offset:640
    ds_read_b64 v[76:77], v31 offset:768
    ds_read_b64 v[78:79], v31 offset:896
    s_waitcnt lgkmcnt(6)
    v_pk_add_f32 v[64:65], v[64:65], v[66:67]
    s_waitcnt lgkmcnt(4)
    v_pk_add_f32 v[68:69], v[68:69], v[70:71]
    s_waitcnt lgkmcnt(2)
    v_pk_add_f32 v[72:73], v[72:73], v[74:75]
    s_waitcnt lgkmcnt(0)
    v_pk_add_f32 v[76:77], v[76:77], v[78:79]
    v_pk_add_f32 v[64:65], v[64:65], v[68:69]
    v_pk_add_f32 v[72:73], v[72:73], v[76:77]
    v_pk_add_f32 v[64:65], v[64:65], v[72:73]
    v_pk_fma_f32 v[64:65], v[64:65], v[52:53], v[48:49]
    s_mov_b64 exec, 0xffff
    v_cvt_pk_bf16_f32 v64, v64, v65
    buffer_store_dword v64, v192, s[68:71], s64 offen
    s_mov_b64 exec, -1
    s_endpgm
L_d_epoch:
    s_lshl2_add_u32 s77, s2, s3
    s_cmpk_lg_u32 s77, 513
    s_cbranch_scc1 L_done
    s_mov_b32 s77, 671744
    s_mov_b64 exec, 1
    buffer_store_dword v61, v8, s[36:39], s77 offen sc1
    s_mov_b64 exec, -1
    s_branch L_done
L_ls_1:
    buffer_store_dwordx2 v[42:43], v19, s[36:39], s81 offen sc1
    s_branch L_ls_2
L_ls_3:
    buffer_store_dwordx4 v[56:59], v20, s[36:39], s82 offen sc1
    s_branch L_ls_4
L_front:
    s_setprio 3
    v_mov_b32 v13, 0
    s_mov_b32 s80, 671744
    s_mov_b32 s38, 268435456
    s_mov_b32 s39, 0x00020000
    s_waitcnt lgkmcnt(0)
    s_mov_b64 s[36:37], s[34:35]
    buffer_load_dword v15, v13, s[36:39], s80 offen sc1
    v_mov_b32 v14, 145536
    ds_write_b32 v14, v13
    s_cmp_lg_u32 s5, 0
    s_cbranch_scc1 L_f_noprobe
    s_lshl3_add_u32 s77, s2, s3
    s_lshr_b32 s78, s77, 7
    s_lshl_b32 s78, s78, 14
    s_and_b32 s77, s77, 127
    s_lshl_b32 s77, s77, 6
    s_add_u32 s77, s77, s78
    s_add_u32 s77, s77, 720896
    s_add_u32 s32, s34, s77
    s_addc_u32 s33, s35, 0
    s_load_dword s18, s[32:33], 0 glc
    s_load_dword s19, s[32:33], 8192 glc
L_f_noprobe:
    s_mov_b32 s63, 0
    s_mov_b32 s83, 0xffff0000
    s_getreg_b32 s72, hwreg(HW_REG_XCC_ID, 0, 4)
    s_bfe_u32 s56, s72, 0x10002
    s_lshl_b32 s60, s4, 8
    s_add_u32 s60, s60, 675840
    s_lshl2_add_u32 s77, s5, s60
    v_and_b32 v19, 31, v0
    v_lshlrev_b32 v20, 7, v19
    v_lshlrev_b32 v19, 2, v19
    v_add_u32 v17, 131072, v8
    s_lshl_b32 s62, s4, 16
    s_add_u32 s62, s62, 1081344
    s_waitcnt vmcnt(0) lgkmcnt(0)
    v_readfirstlane_b32 s73, v15
    s_nop 0
    s_mul_i32 s73, s73, 1664525
    s_add_u32 s73, s73, 1013904223
    s_xor_b32 s72, s72, s73
    v_mov_b32 v22, s72
    v_mov_b32 v25, s73
    s_cmp_lt_u32 s5, 28
    s_cbranch_scc1 L_f_post
    s_barrier
L_f_post:
    s_mov_b64 exec, 1
    buffer_store_dword v22, v13, s[36:39], s77 offen
    s_mov_b64 exec, -1
    s_cmp_lg_u32 s96, 0
    s_cbranch_scc1 L_f_qcu
    s_cmp_eq_u32 s5, 0
    s_cbranch_scc1 L_f_vote
    s_sleep 20
L_f_ids:
    s_mov_b32 s79, 0
    s_mov_b32 s58, 1
L_id_again:
    buffer_load_dword v23, v19, s[36:39], s60 offen sc1
    s_waitcnt vmcnt(0)
    v_cmp_ne_u32 vcc, s72, v23
    s_cbranch_vccnz L_id_slow
L_id_ok:
    s_cmp_lg_u32 s96, 0
    s_cbranch_scc1 L_f_qpub
    s_cmp_eq_u32 s5, 0
    s_cbranch_scc1 L_f_gr
    s_sleep 8
L_f_gather:
    s_lshl_b32 s77, s6, 10
    s_add_u32 s62, s62, s77
    s_mov_b32 s79, 0
L_q_retry:
    buffer_load_dwordx4 v[28:31], v8, s[36:39], s62 offen sc1
    s_waitcnt vmcnt(0)
    v_max3_u32 v1, v28, v29, v30
    v_max_u32 v1, v1, v31
    v_cmp_eq_u32 vcc, -1, v1
    s_cbranch_vccz L_q_ok
    s_add_u32 s79, s79, 1
    s_cmp_lt_u32 s79, 65536
    s_cbranch_scc1 L_q_retry
L_q_ok:
    ds_write_b128 v17, v[28:31]
    s_or_b32 s58, s58, 2
    v_mov_b32 v24, s58
    ds_write_b64 v14, v[24:25]
    s_waitcnt lgkmcnt(0)
    s_barrier
    s_endpgm
L_id_slow:
    s_sleep 4
    s_add_u32 s79, s79, 1
    s_cmp_lt_u32 s79, 12
    s_cbranch_scc1 L_id_again
    s_lshl_b32 s59, s4, 12
    s_add_u32 s59, s59, 688128
    s_cmp_lg_u32 s79, 12
    s_cbranch_scc1 L_id_posted
    s_lshl_b32 s76, s5, 7
    s_add_u32 s76, s76, s59
    s_mov_b64 exec, 1
    buffer_store_dword v22, v13, s[36:39], s76 offen sc1
    s_mov_b64 exec, -1
L_id_posted:
    buffer_load_dword v23, v20, s[36:39], s59 offen sc1
    s_waitcnt vmcnt(0)
    v_xor_b32 v1, s73, v23
    v_cmp_lt_u32 vcc, 15, v1
    s_cbranch_vccz L_id_all
    s_cmp_lt_u32 s79, 65536
    s_cbranch_scc1 L_id_again
L_id_all:
    s_mov_b32 s58, 0
    s_branch L_id_ok
L_f_vote:
    s_mov_b64 s[10:11], -1
    s_memtime s[14:15]
    s_load_dword s18, s[32:33], 0 glc
    s_waitcnt lgkmcnt(0)
    s_memtime s[16:17]
    s_waitcnt lgkmcnt(0)
    s_sub_u32 s12, s16, s14
    s_min_u32 s10, s10, s12
    s_load_dword s18, s[32:33], 8192 glc
    s_waitcnt lgkmcnt(0)
    s_memtime s[14:15]
    s_waitcnt lgkmcnt(0)
    s_sub_u32 s12, s14, s16
    s_min_u32 s11, s11, s12
    s_load_dword s18, s[32:33], 0 glc
    s_waitcnt lgkmcnt(0)
    s_memtime s[16:17]
    s_waitcnt lgkmcnt(0)
    s_sub_u32 s12, s16, s14
    s_min_u32 s10, s10, s12
    s_load_dword s18, s[32:33], 8192 glc
    s_waitcnt lgkmcnt(0)
    s_memtime s[14:15]
    s_waitcnt lgkmcnt(0)
    s_sub_u32 s12, s14, s16
    s_min_u32 s11, s11, s12
    s_cmp_lt_u32 s10, s11
    s_cselect_b32 s63, 0, 8192
    s_lshr_b32 s63, s63, 13
    s_xor_b32 s63, s63, s56
    v_xor_b32 v26, s63, v25
    s_branch L_f_ids
L_f_gr:
    s_lshl_b32 s76, s4, 7
    s_add_u32 s76, s76, 679936
    s_mov_b64 exec, 1
    buffer_store_dword v26, v13, s[36:39], s76 offen sc1
    s_mov_b64 exec, -1
    s_branch L_f_gather
L_f_qpub:
    v_add_u32 v16, 140288, v8
    v_lshlrev_b32 v18, 3, v7
    v_lshl_add_u32 v18, v3, 10, v18
    s_lshl_b32 s77, s7, 7
    s_add_u32 s77, s77, s62
    s_barrier
    ds_read_b128 v[64:67], v16 offset:0
    ds_read_b128 v[68:71], v16 offset:1024
    ds_read_b128 v[72:75], v16 offset:2048
    ds_read_b128 v[76:79], v16 offset:3072
    s_waitcnt lgkmcnt(2)
    v_pk_add_f32 v[64:65], v[64:65], v[68:69]
    v_pk_add_f32 v[66:67], v[66:67], v[70:71]
    s_waitcnt lgkmcnt(0)
    v_pk_add_f32 v[72:73], v[72:73], v[76:77]
    v_pk_add_f32 v[74:75], v[74:75], v[78:79]
    v_pk_add_f32 v[64:65], v[64:65], v[72:73]
    v_pk_add_f32 v[66:67], v[66:67], v[74:75]
    v_cvt_pk_bf16_f32 v26, v64, v65
    v_cvt_pk_bf16_f32 v27, v66, v67
    s_cmp_eq_u32 s58, 0
    s_cbranch_scc1 L_ls_5
    buffer_store_dwordx2 v[26:27], v18, s[36:39], s77 offen
L_ls_6:
    s_barrier
    s_branch L_f_gather
L_ls_5:
    buffer_store_dwordx2 v[26:27], v18, s[36:39], s77 offen sc1
    s_branch L_ls_6
L_f_qcu:
    s_cmp_ge_u32 s7, 4
    s_cbranch_scc1 L_f_q2
    v_lshrrev_b32 v1, 3, v0
    v_and_b32 v18, 1, v0
    v_lshl_add_u32 v1, v1, 1, v18
    v_bfe_u32 v21, v0, 1, 2
    v_lshlrev_b32 v16, 3, v1
    v_lshl_add_u32 v16, v21, 7, v16
    v_add_u32 v16, 142336, v16
    s_lshl2_add_u32 s61, s4, s7
    v_lshlrev_b32 v21, 3, v0
    s_lshl_b32 s61, s61, 9
    s_add_u32 s61, s61, 655360
    s_cmp_lt_u32 s4, 4
    s_barrier
    ds_read_b64 v[64:65], v16 offset:0
    ds_read_b64 v[66:67], v16 offset:512
    ds_read_b64 v[68:69], v16 offset:1024
    ds_read_b64 v[70:71], v16 offset:1536
    s_waitcnt lgkmcnt(2)
    v_pk_add_f32 v[64:65], v[64:65], v[66:67]
    s_waitcnt lgkmcnt(0)
    v_pk_add_f32 v[68:69], v[68:69], v[70:71]
    v_pk_add_f32 v[64:65], v[64:65], v[68:69]
    s_cbranch_scc1 L_f_h_sa
    v_cvt_pk_bf16_f32 v40, v64, v65
    v_lshlrev_b32 v64, 16, v40
    v_and_b32 v65, s83, v40
    v_pk_add_f32 v[64:65], v[64:65], 1.0 op_sel_hi:[1,0]
L_f_h_sa:
    v_cvt_pk_bf16_f32 v24, v64, v65
    buffer_store_dwordx2 v[24:25], v21, s[36:39], s61 offen sc1
    s_barrier
    s_branch L_f_ids
L_f_q2:
    s_sleep 20
    s_branch L_f_ids
L_qcu:
    s_mov_b64 s[36:37], s[34:35]
    s_mov_b32 s38, 268435456
    s_mov_b32 s39, s43
    s_mov_b32 s77, 671744
    v_mov_b32 v14, 0
    buffer_load_dword v15, v14, s[36:39], s77 offen sc1
    s_mov_b32 s83, 0xffff0000
    v_add_u32 v13, s82, v8
    v_add_u32 v13, 136192, v13
    v_and_b32 v1, 7, v0
    v_lshlrev_b32 v9, 1, v3
    v_xor_b32 v1, v1, v9
    v_lshrrev_b32 v9, 3, v0
    v_lshlrev_b32 v9, 13, v9
    v_lshl_add_u32 v9, v1, 4, v9
    s_add_u32 s81, s82, s4
    s_lshl3_add_u32 s81, s81, s7
    s_lshl_b32 s81, s81, 7
    s_mov_b32 s59, 1073741824
    s_cmp_lt_u32 s7, 4
    s_cbranch_scc1 L_mload
    s_add_u32 s79, s79, 3014656
    buffer_load_dwordx4 v[196:199], v8, s[52:55], s79 offen
    s_add_u32 s79, s79, 131072
    buffer_load_dwordx4 v[196:199], v8, s[52:55], s79 offen
    s_add_u32 s75, s75, 376832
    buffer_load_dwordx4 v[196:199], v8, s[40:43], s75 offen
    s_add_u32 s75, s75, 16384
    buffer_load_dwordx4 v[196:199], v8, s[40:43], s75 offen
    v_mov_b32 v32, -1
    v_mov_b32 v33, -1
    v_mov_b32 v34, -1
    v_mov_b32 v35, -1
    s_and_b32 s77, s99, 15
    s_lshl4_add_u32 s57, s4, s77
    s_lshl_b32 s57, s57, 12
    s_add_u32 s57, s57, 1048576
    s_and_b32 s78, s77, 1
    s_cmp_lt_u32 s77, 10
    s_cselect_b32 s59, s57, s59
    s_and_b32 s56, s4, 6
    s_add_u32 s56, s56, s4
    s_lshl1_add_u32 s56, s78, s56
    s_lshl_b32 s56, s56, 12
    s_cmp_ge_u32 s77, 10
    s_cselect_b32 s57, s56, s57
    s_lshl_b32 s56, s78, 18
    s_add_u32 s56, s56, s4
    s_lshl_b32 s56, s56, 12
    s_add_u32 s56, s56, 65536
    s_cmp_ge_u32 s77, 12
    s_cselect_b32 s57, s56, s57
    s_and_b32 s56, s4, 4
    s_add_u32 s56, s56, s4
    s_lshl2_add_u32 s56, s78, s56
    s_lshl_b32 s56, s56, 11
    s_add_u32 s56, s56, 131072
    s_cmp_ge_u32 s77, 14
    s_cselect_b32 s57, s56, s57
    s_cselect_b32 s58, 1073741824, s57
    buffer_store_dwordx4 v[32:35], v8, s[36:39], s57 offen offset:0 sc1
    buffer_store_dwordx4 v[32:35], v8, s[36:39], s57 offen offset:1024 sc1
    buffer_store_dwordx4 v[32:35], v8, s[36:39], s58 offen offset:2048 sc1
    buffer_store_dwordx4 v[32:35], v8, s[36:39], s58 offen offset:3072 sc1
    s_lshl_b32 s80, s3, 14
    s_add_u32 s80, s80, 65536
    s_waitcnt vmcnt(10)
    v_lshlrev_b32 v40, 16, v24
    v_and_b32 v41, s83, v24
    v_lshlrev_b32 v42, 16, v25
    v_and_b32 v43, s83, v25
    v_lshlrev_b32 v44, 16, v26
    v_and_b32 v45, s83, v26
    v_lshlrev_b32 v46, 16, v27
    v_and_b32 v47, s83, v27
    v_mul_f32 v48, 0xbfb8aa3b, v40
    v_mul_f32 v49, 0xbfb8aa3b, v41
    v_mul_f32 v50, 0xbfb8aa3b, v42
    v_mul_f32 v51, 0xbfb8aa3b, v43
    v_mul_f32 v52, 0xbfb8aa3b, v44
    v_mul_f32 v53, 0xbfb8aa3b, v45
    v_mul_f32 v54, 0xbfb8aa3b, v46
    v_mul_f32 v55, 0xbfb8aa3b, v47
    v_exp_f32 v48, v48
    v_exp_f32 v49, v49
    v_exp_f32 v50, v50
    v_exp_f32 v51, v51
    v_exp_f32 v52, v52
    v_exp_f32 v53, v53
    v_exp_f32 v54, v54
    v_exp_f32 v55, v55
    v_add_f32 v48, 1.0, v48
    v_add_f32 v49, 1.0, v49
    v_add_f32 v50, 1.0, v50
    v_add_f32 v51, 1.0, v51
    v_add_f32 v52, 1.0, v52
    v_add_f32 v53, 1.0, v53
    v_add_f32 v54, 1.0, v54
    v_add_f32 v55, 1.0, v55
    v_rcp_f32 v48, v48
    v_rcp_f32 v49, v49
    v_rcp_f32 v50, v50
    v_rcp_f32 v51, v51
    v_rcp_f32 v52, v52
    v_rcp_f32 v53, v53
    v_rcp_f32 v54, v54
    v_rcp_f32 v55, v55
    v_mul_f32 v48, v48, v40
    v_mul_f32 v49, v49, v41
    v_mul_f32 v50, v50, v42
    v_mul_f32 v51, v51, v43
    v_mul_f32 v52, v52, v44
    v_mul_f32 v53, v53, v45
    v_mul_f32 v54, v54, v46
    v_mul_f32 v55, v55, v47
    v_cvt_pk_bf16_f32 v248, v48, v49
    v_cvt_pk_bf16_f32 v249, v50, v51
    v_cvt_pk_bf16_f32 v250, v52, v53
    v_cvt_pk_bf16_f32 v251, v54, v55
    s_waitcnt vmcnt(9)
    v_lshlrev_b32 v40, 16, v28
    v_and_b32 v41, s83, v28
    v_lshlrev_b32 v42, 16, v29
    v_and_b32 v43, s83, v29
    v_lshlrev_b32 v44, 16, v30
    v_and_b32 v45, s83, v30
    v_lshlrev_b32 v46, 16, v31
    v_and_b32 v47, s83, v31
    v_pk_add_f32 v[48:49], v[40:41], v[42:43]
    v_pk_add_f32 v[50:51], v[44:45], v[46:47]
    v_pk_add_f32 v[48:49], v[48:49], v[50:51]
    v_add_f32 v48, v48, v49
    s_nop 1
    v_add_f32_dpp v48, v48, v48 row_ror:1 row_mask:0xf bank_mask:0xf
    s_nop 1
    v_add_f32_dpp v48, v48, v48 row_ror:2 row_mask:0xf bank_mask:0xf
    s_nop 1
    v_add_f32_dpp v48, v48, v48 row_ror:4 row_mask:0xf bank_mask:0xf
    s_nop 1
    v_add_f32_dpp v48, v48, v48 row_ror:8 row_mask:0xf bank_mask:0xf
    v_mov_b32 v49, v48
    s_nop 1
    v_permlane16_swap_b32 v48, v49
    v_add_f32 v48, v48, v49
    v_mov_b32 v49, v48
    s_nop 1
    v_permlane32_swap_b32 v48, v49
    v_add_f32 v48, v48, v49
    v_mul_f32 v48, 0x3b000000, v48
    v_sub_f32 v52, v40, v48
    v_sub_f32 v53, v41, v48
    v_sub_f32 v54, v42, v48
    v_sub_f32 v55, v43, v48
    v_sub_f32 v56, v44, v48
    v_sub_f32 v57, v45, v48
    v_sub_f32 v58, v46, v48
    v_sub_f32 v59, v47, v48
    v_mul_f32 v49, v52, v52
    v_fmac_f32 v49, v53, v53
    v_fmac_f32 v49, v54, v54
    v_fmac_f32 v49, v55, v55
    v_fmac_f32 v49, v56, v56
    v_fmac_f32 v49, v57, v57
    v_fmac_f32 v49, v58, v58
    v_fmac_f32 v49, v59, v59
    s_nop 1
    v_add_f32_dpp v49, v49, v49 row_ror:1 row_mask:0xf bank_mask:0xf
    s_nop 1
    v_add_f32_dpp v49, v49, v49 row_ror:2 row_mask:0xf bank_mask:0xf
    s_nop 1
    v_add_f32_dpp v49, v49, v49 row_ror:4 row_mask:0xf bank_mask:0xf
    s_nop 1
    v_add_f32_dpp v49, v49, v49 row_ror:8 row_mask:0xf bank_mask:0xf
    v_mov_b32 v50, v49
    s_nop 1
    v_permlane16_swap_b32 v49, v50
    v_add_f32 v49, v49, v50
    v_mov_b32 v50, v49
    s_nop 1
    v_permlane32_swap_b32 v49, v50
    v_add_f32 v49, v49, v50
    v_mul_f32 v49, 0x3b000000, v49
    v_cvt_pk_bf16_f32 v50, v48, v49
    v_lshlrev_b32 v48, 16, v50
    v_and_b32 v49, s83, v50
    v_add_f32 v49, 0x3727c5ac, v49
    v_cvt_pk_bf16_f32 v50, v48, v49
    v_lshlrev_b32 v48, 16, v50
    v_and_b32 v49, s83, v50
    v_sqrt_f32 v49, v49
    s_nop 0
    v_cvt_pk_bf16_f32 v50, v48, v49
    v_lshlrev_b32 v48, 16, v50
    v_and_b32 v49, s83, v50
    v_rcp_f32 v49, v49
    v_sub_f32 v40, v40, v48
    v_sub_f32 v41, v41, v48
    v_sub_f32 v42, v42, v48
    v_sub_f32 v43, v43, v48
    v_sub_f32 v44, v44, v48
    v_sub_f32 v45, v45, v48
    v_sub_f32 v46, v46, v48
    v_sub_f32 v47, v47, v48
    v_cvt_pk_bf16_f32 v52, v40, v41
    v_cvt_pk_bf16_f32 v53, v42, v43
    v_cvt_pk_bf16_f32 v54, v44, v45
    v_cvt_pk_bf16_f32 v55, v46, v47
    v_lshlrev_b32 v40, 16, v52
    v_and_b32 v41, s83, v52
    v_lshlrev_b32 v42, 16, v53
    v_and_b32 v43, s83, v53
    v_lshlrev_b32 v44, 16, v54
    v_and_b32 v45, s83, v54
    v_lshlrev_b32 v46, 16, v55
    v_and_b32 v47, s83, v55
    v_mul_f32 v40, v40, v49
    v_mul_f32 v41, v41, v49
    v_mul_f32 v42, v42, v49
    v_mul_f32 v43, v43, v49
    v_mul_f32 v44, v44, v49
    v_mul_f32 v45, v45, v49
    v_mul_f32 v46, v46, v49
    v_mul_f32 v47, v47, v49
    v_cvt_pk_bf16_f32 v28, v40, v41
    v_cvt_pk_bf16_f32 v29, v42, v43
    v_cvt_pk_bf16_f32 v30, v44, v45
    v_cvt_pk_bf16_f32 v31, v46, v47
    ds_write_b128 v13, v[28:31]
    s_waitcnt vmcnt(0) lgkmcnt(0)
    s_barrier
    s_mov_b32 s74, 64512
    s_add_u32 m0, s80, 0
    s_nop 0
    buffer_load_dwordx4 v9, s[52:55], s81 offen offset:0 nt lds
    s_add_u32 s81, s81, s74
    buffer_load_dwordx4 v9, s[52:55], s81 offen offset:1024 nt lds
    s_add_u32 s81, s81, s74
    buffer_load_dwordx4 v9, s[52:55], s81 offen offset:2048 nt lds
    s_add_u32 s81, s81, s74
    buffer_load_dwordx4 v9, s[52:55], s81 offen offset:3072 nt lds
    s_add_u32 s81, s81, 68608
    s_branch L_qload
L_mload:
    v_and_b32 v12, 1, v3
    v_lshlrev_b32 v1, 1, v12
    v_xor_b32 v1, v1, v4
    v_lshrrev_b32 v11, 2, v0
    v_mul_u32_u24 v10, 6144, v11
    v_lshl_add_u32 v10, v1, 4, v10
    s_lshl_b32 s80, s3, 13
    s_lshl2_add_u32 s78, s4, s7
    s_lshl_b32 s78, s78, 6
    s_mul_i32 s79, s3, 786432
    s_add_u32 s79, s79, s78
    s_mov_b32 s74, 97280
    s_add_u32 m0, s80, 0
    s_nop 0
    buffer_load_dwordx4 v10, s[48:51], s79 offen offset:0 lds
    s_add_u32 s79, s79, s74
    buffer_load_dwordx4 v10, s[48:51], s79 offen offset:1024 lds
    s_add_u32 s79, s79, s74
    buffer_load_dwordx4 v10, s[48:51], s79 offen offset:2048 lds
    s_add_u32 s79, s79, s74
    buffer_load_dwordx4 v10, s[48:51], s79 offen offset:3072 lds
    s_add_u32 s79, s79, s74
    s_add_u32 s79, s79, 4096
    s_add_u32 m0, s80, 4096
    s_nop 0
    buffer_load_dwordx4 v10, s[48:51], s79 offen offset:0 lds
    s_add_u32 s79, s79, s74
    buffer_load_dwordx4 v10, s[48:51], s79 offen offset:1024 lds
    s_add_u32 s79, s79, s74
    s_lshl_b32 s77, s3, 8
    v_lshlrev_b32 v22, 6, v11
    v_lshl_add_u32 v22, v12, 5, v22
    v_lshl_add_u32 v22, v4, 3, v22
    v_add_u32 v22, s80, v22
    v_lshlrev_b32 v20, 2, v7
    v_lshl_add_u32 v20, v3, 7, v20
    s_lshl1_add_u32 s77, s77, 142336
    v_add_u32 v20, s77, v20
    s_waitcnt vmcnt(8)
    buffer_load_dwordx4 v10, s[48:51], s79 offen offset:2048 lds
    s_add_u32 s79, s79, s74
    buffer_load_dwordx4 v10, s[48:51], s79 offen offset:3072 lds
    v_xor_b32 v23, 32, v22
    v_lshlrev_b32 v40, 16, v24
    v_and_b32 v41, s83, v24
    v_lshlrev_b32 v42, 16, v25
    v_and_b32 v43, s83, v25
    v_lshlrev_b32 v44, 16, v26
    v_and_b32 v45, s83, v26
    v_lshlrev_b32 v46, 16, v27
    v_and_b32 v47, s83, v27
    v_mul_f32 v48, 0xbfb8aa3b, v40
    v_mul_f32 v49, 0xbfb8aa3b, v41
    v_mul_f32 v50, 0xbfb8aa3b, v42
    v_mul_f32 v51, 0xbfb8aa3b, v43
    v_mul_f32 v52, 0xbfb8aa3b, v44
    v_mul_f32 v53, 0xbfb8aa3b, v45
    v_mul_f32 v54, 0xbfb8aa3b, v46
    v_mul_f32 v55, 0xbfb8aa3b, v47
    v_exp_f32 v48, v48
    v_exp_f32 v49, v49
    v_exp_f32 v50, v50
    v_exp_f32 v51, v51
    v_exp_f32 v52, v52
    v_exp_f32 v53, v53
    v_exp_f32 v54, v54
    v_exp_f32 v55, v55
    v_add_f32 v48, 1.0, v48
    v_add_f32 v49, 1.0, v49
    v_add_f32 v50, 1.0, v50
    v_add_f32 v51, 1.0, v51
    v_add_f32 v52, 1.0, v52
    v_add_f32 v53, 1.0, v53
    v_add_f32 v54, 1.0, v54
    v_add_f32 v55, 1.0, v55
    v_rcp_f32 v48, v48
    v_rcp_f32 v49, v49
    v_rcp_f32 v50, v50
    v_rcp_f32 v51, v51
    v_rcp_f32 v52, v52
    v_rcp_f32 v53, v53
    v_rcp_f32 v54, v54
    v_rcp_f32 v55, v55
    v_mul_f32 v48, v48, v40
    v_mul_f32 v49, v49, v41
    v_mul_f32 v50, v50, v42
    v_mul_f32 v51, v51, v43
    v_mul_f32 v52, v52, v44
    v_mul_f32 v53, v53, v45
    v_mul_f32 v54, v54, v46
    v_mul_f32 v55, v55, v47
    v_cvt_pk_bf16_f32 v248, v48, v49
    v_cvt_pk_bf16_f32 v249, v50, v51
    v_cvt_pk_bf16_f32 v250, v52, v53
    v_cvt_pk_bf16_f32 v251, v54, v55
    s_lshl_b32 s80, s3, 14
    s_add_u32 s80, s80, 65536
    s_waitcnt vmcnt(0)
    ds_read_b64_tr_b16 v[128:129], v22 offset:0
    ds_read_b64_tr_b16 v[130:131], v22 offset:1024
    ds_read_b64_tr_b16 v[132:133], v22 offset:2048
    ds_read_b64_tr_b16 v[134:135], v22 offset:3072
    ds_read_b64_tr_b16 v[136:137], v22 offset:4096
    ds_read_b64_tr_b16 v[138:139], v22 offset:5120
    ds_read_b64_tr_b16 v[140:141], v22 offset:6144
    ds_read_b64_tr_b16 v[142:143], v22 offset:7168
    s_waitcnt lgkmcnt(4)
    ds_read_b64_tr_b16 v[144:145], v23 offset:0
    ds_read_b64_tr_b16 v[146:147], v23 offset:1024
    ds_read_b64_tr_b16 v[148:149], v23 offset:2048
    ds_read_b64_tr_b16 v[150:151], v23 offset:3072
    ds_read_b64_tr_b16 v[152:153], v23 offset:4096
    ds_read_b64_tr_b16 v[154:155], v23 offset:5120
    ds_read_b64_tr_b16 v[156:157], v23 offset:6144
    ds_read_b64_tr_b16 v[158:159], v23 offset:7168
    s_mov_b32 s74, 64512
    s_add_u32 m0, s80, 0
    s_nop 0
    buffer_load_dwordx4 v9, s[52:55], s81 offen offset:0 nt lds
    s_add_u32 s81, s81, s74
    buffer_load_dwordx4 v9, s[52:55], s81 offen offset:1024 nt lds
    s_add_u32 s81, s81, s74
    buffer_load_dwordx4 v9, s[52:55], s81 offen offset:2048 nt lds
    s_add_u32 s81, s81, s74
    buffer_load_dwordx4 v9, s[52:55], s81 offen offset:3072 nt lds
    s_add_u32 s81, s81, 68608
    s_waitcnt lgkmcnt(8)
    v_mfma_f32_16x16x32_bf16 v[32:35], v[248:251], v[128:131], 0
    v_mfma_f32_16x16x32_bf16 v[36:39], v[248:251], v[132:135], 0
    v_mfma_f32_16x16x32_bf16 v[40:43], v[248:251], v[136:139], 0
    v_mfma_f32_16x16x32_bf16 v[44:47], v[248:251], v[140:143], 0
    s_waitcnt lgkmcnt(0)
    v_mfma_f32_16x16x32_bf16 v[48:51], v[248:251], v[144:147], 0
    v_mfma_f32_16x16x32_bf16 v[52:55], v[248:251], v[148:151], 0
    v_mfma_f32_16x16x32_bf16 v[56:59], v[248:251], v[152:155], 0
    v_mfma_f32_16x16x32_bf16 v[60:63], v[248:251], v[156:159], 0
    s_nop 0
    v_add_f32 v32, v32, v37
    s_nop 0
    v_add_f32 v42, v42, v47
    v_add_f32 v32, v32, v42
    s_nop 0
    v_add_f32 v48, v48, v53
    s_nop 0
    v_add_f32 v58, v58, v63
    v_add_f32 v48, v48, v58
    ds_write2_b32 v20, v32, v48 offset0:0 offset1:16
    s_waitcnt lgkmcnt(0)
    s_barrier
    v_lshlrev_b32 v40, 16, v28
    v_and_b32 v41, s83, v28
    v_lshlrev_b32 v42, 16, v29
    v_and_b32 v43, s83, v29
    v_lshlrev_b32 v44, 16, v30
    v_and_b32 v45, s83, v30
    v_lshlrev_b32 v46, 16, v31
    v_and_b32 v47, s83, v31
    v_pk_add_f32 v[48:49], v[40:41], v[42:43]
    v_pk_add_f32 v[50:51], v[44:45], v[46:47]
    v_pk_add_f32 v[48:49], v[48:49], v[50:51]
    v_add_f32 v48, v48, v49
    s_nop 1
    v_add_f32_dpp v48, v48, v48 row_ror:1 row_mask:0xf bank_mask:0xf
    s_nop 1
    v_add_f32_dpp v48, v48, v48 row_ror:2 row_mask:0xf bank_mask:0xf
    s_nop 1
    v_add_f32_dpp v48, v48, v48 row_ror:4 row_mask:0xf bank_mask:0xf
    s_nop 1
    v_add_f32_dpp v48, v48, v48 row_ror:8 row_mask:0xf bank_mask:0xf
    v_mov_b32 v49, v48
    s_nop 1
    v_permlane16_swap_b32 v48, v49
    v_add_f32 v48, v48, v49
    v_mov_b32 v49, v48
    s_nop 1
    v_permlane32_swap_b32 v48, v49
    v_add_f32 v48, v48, v49
    v_mul_f32 v48, 0x3b000000, v48
    v_sub_f32 v52, v40, v48
    v_sub_f32 v53, v41, v48
    v_sub_f32 v54, v42, v48
    v_sub_f32 v55, v43, v48
    v_sub_f32 v56, v44, v48
    v_sub_f32 v57, v45, v48
    v_sub_f32 v58, v46, v48
    v_sub_f32 v59, v47, v48
    v_mul_f32 v49, v52, v52
    v_fmac_f32 v49, v53, v53
    v_fmac_f32 v49, v54, v54
    v_fmac_f32 v49, v55, v55
    v_fmac_f32 v49, v56, v56
    v_fmac_f32 v49, v57, v57
    v_fmac_f32 v49, v58, v58
    v_fmac_f32 v49, v59, v59
    s_nop 1
    v_add_f32_dpp v49, v49, v49 row_ror:1 row_mask:0xf bank_mask:0xf
    s_nop 1
    v_add_f32_dpp v49, v49, v49 row_ror:2 row_mask:0xf bank_mask:0xf
    s_nop 1
    v_add_f32_dpp v49, v49, v49 row_ror:4 row_mask:0xf bank_mask:0xf
    s_nop 1
    v_add_f32_dpp v49, v49, v49 row_ror:8 row_mask:0xf bank_mask:0xf
    v_mov_b32 v50, v49
    s_nop 1
    v_permlane16_swap_b32 v49, v50
    v_add_f32 v49, v49, v50
    v_mov_b32 v50, v49
    s_nop 1
    v_permlane32_swap_b32 v49, v50
    v_add_f32 v49, v49, v50
    v_mul_f32 v49, 0x3b000000, v49
    v_cvt_pk_bf16_f32 v50, v48, v49
    v_lshlrev_b32 v48, 16, v50
    v_and_b32 v49, s83, v50
    v_add_f32 v49, 0x3727c5ac, v49
    v_cvt_pk_bf16_f32 v50, v48, v49
    v_lshlrev_b32 v48, 16, v50
    v_and_b32 v49, s83, v50
    v_sqrt_f32 v49, v49
    s_nop 0
    v_cvt_pk_bf16_f32 v50, v48, v49
    v_lshlrev_b32 v48, 16, v50
    v_and_b32 v49, s83, v50
    v_rcp_f32 v49, v49
    v_sub_f32 v40, v40, v48
    v_sub_f32 v41, v41, v48
    v_sub_f32 v42, v42, v48
    v_sub_f32 v43, v43, v48
    v_sub_f32 v44, v44, v48
    v_sub_f32 v45, v45, v48
    v_sub_f32 v46, v46, v48
    v_sub_f32 v47, v47, v48
    v_cvt_pk_bf16_f32 v52, v40, v41
    v_cvt_pk_bf16_f32 v53, v42, v43
    v_cvt_pk_bf16_f32 v54, v44, v45
    v_cvt_pk_bf16_f32 v55, v46, v47
    v_lshlrev_b32 v40, 16, v52
    v_and_b32 v41, s83, v52
    v_lshlrev_b32 v42, 16, v53
    v_and_b32 v43, s83, v53
    v_lshlrev_b32 v44, 16, v54
    v_and_b32 v45, s83, v54
    v_lshlrev_b32 v46, 16, v55
    v_and_b32 v47, s83, v55
    v_mul_f32 v40, v40, v49
    v_mul_f32 v41, v41, v49
    v_mul_f32 v42, v42, v49
    v_mul_f32 v43, v43, v49
    v_mul_f32 v44, v44, v49
    v_mul_f32 v45, v45, v49
    v_mul_f32 v46, v46, v49
    v_mul_f32 v47, v47, v49
    v_cvt_pk_bf16_f32 v28, v40, v41
    v_cvt_pk_bf16_f32 v29, v42, v43
    v_cvt_pk_bf16_f32 v30, v44, v45
    v_cvt_pk_bf16_f32 v31, v46, v47
    ds_write_b128 v13, v[28:31]
    s_waitcnt lgkmcnt(0)
    s_barrier
L_qload:
    s_mov_b32 s74, 64512
    s_add_u32 m0, s80, 4096
    s_nop 0
    buffer_load_dwordx4 v9, s[52:55], s81 offen offset:0 nt lds
    s_add_u32 s81, s81, s74
    buffer_load_dwordx4 v9, s[52:55], s81 offen offset:1024 nt lds
    s_add_u32 s81, s81, s74
    buffer_load_dwordx4 v9, s[52:55], s81 offen offset:2048 nt lds
    s_add_u32 s81, s81, s74
    buffer_load_dwordx4 v9, s[52:55], s81 offen offset:3072 nt lds
    s_add_u32 s81, s81, 68608
    s_add_u32 m0, s80, 8192
    s_nop 0
    buffer_load_dwordx4 v9, s[52:55], s81 offen offset:0 nt lds
    s_add_u32 s81, s81, s74
    s_waitcnt vmcnt(7)
    buffer_load_dwordx4 v9, s[52:55], s81 offen offset:1024 nt lds
    s_add_u32 s81, s81, s74
    s_waitcnt vmcnt(7)
    buffer_load_dwordx4 v9, s[52:55], s81 offen offset:2048 nt lds
    s_add_u32 s81, s81, s74
    s_waitcnt vmcnt(7)
    buffer_load_dwordx4 v9, s[52:55], s81 offen offset:3072 nt lds
    s_add_u32 s81, s81, 68608
    s_waitcnt vmcnt(7)
    s_add_u32 m0, s80, 12288
    s_nop 0
    buffer_load_dwordx4 v9, s[52:55], s81 offen offset:0 nt lds
    s_add_u32 s81, s81, s74
    s_waitcnt vmcnt(7)
    buffer_load_dwordx4 v9, s[52:55], s81 offen offset:1024 nt lds
    s_add_u32 s81, s81, s74
    s_waitcnt vmcnt(7)
    buffer_load_dwordx4 v9, s[52:55], s81 offen offset:2048 nt lds
    s_add_u32 s81, s81, s74
    s_waitcnt vmcnt(7)
    buffer_load_dwordx4 v9, s[52:55], s81 offen offset:3072 nt lds
    s_waitcnt vmcnt(7)
    v_lshrrev_b32 v1, 2, v7
    v_lshlrev_b32 v16, 9, v1
    v_lshl_add_u32 v16, v3, 6, v16
    v_lshl_add_u32 v16, v4, 4, v16
    s_lshl1_add_u32 s56, s82, 655360
    s_add_u32 s57, s56, 8192
    v_lshlrev_b32 v18, 10, v4
    v_lshl_add_u32 v18, v1, 6, v18
    v_lshl_add_u32 v18, v3, 3, v18
    s_lshr_b32 s77, s82, 2
    s_add_u32 s77, s77, 136192
    v_add_u32 v18, s77, v18
    ds_read2_b64 v[28:31], v18 offset0:0 offset1:4
    s_waitcnt lgkmcnt(0)
    v_lshlrev_b32 v216, 16, v28
    v_and_b32 v217, s83, v28
    v_lshlrev_b32 v218, 16, v29
    v_and_b32 v219, s83, v29
    v_lshlrev_b32 v220, 16, v30
    v_and_b32 v221, s83, v30
    v_lshlrev_b32 v222, 16, v31
    v_and_b32 v223, s83, v31
    v_lshl_add_u32 v18, v4, 2, v1
    v_lshl_add_u32 v18, v18, 2, v3
    v_lshlrev_b32 v18, 4, v18
    s_add_u32 s77, s82, 140288
    v_add_u32 v18, s77, v18
    v_lshrrev_b32 v36, 2, v0
    v_lshlrev_b32 v36, 7, v36
    v_bfe_u32 v1, v0, 3, 2
    v_lshl_add_u32 v36, v1, 5, v36
    v_lshl_add_u32 v36, v4, 3, v36
    v_add_u32 v36, s80, v36
    v_xor_b32 v37, 32, v36
    v_xor_b32 v38, 64, v36
    v_xor_b32 v39, 96, v36
    s_mov_b32 s83, 0xffff0000
    s_lshl_b32 s98, s3, 12
    s_lshl3_add_u32 s76, s6, s4
    s_lshl_b32 s76, s76, 7
    s_add_u32 s76, s76, s7
    s_lshl2_add_u32 s76, s76, s3
    s_addk_i32 s76, 384
    s_lshl_b32 s76, s76, 12
    v_bfe_u32 v1, v0, 2, 2
    v_lshl_add_u32 v1, v1, 4, v3
    v_lshl_add_u32 v1, v1, 2, v4
    v_lshlrev_b32 v2, 4, v1
    v_lshlrev_b32 v6, 6, v0
    s_mov_b32 s79, 0
    s_waitcnt vmcnt(2)
    buffer_load_dword v14, v6, s[36:39], s59 offen sc1
    s_waitcnt vmcnt(1)
    v_readfirstlane_b32 s73, v15
    s_nop 0
    s_mul_i32 s73, s73, 1664525
    s_add_u32 s73, s73, 1013904223
    ds_read_b64_tr_b16 v[128:129], v36 offset:0
    ds_read_b64_tr_b16 v[130:131], v36 offset:2048
    ds_read_b64_tr_b16 v[132:133], v36 offset:4096
    ds_read_b64_tr_b16 v[134:135], v36 offset:6144
    ds_read_b64_tr_b16 v[136:137], v36 offset:8192
    ds_read_b64_tr_b16 v[138:139], v36 offset:10240
    ds_read_b64_tr_b16 v[140:141], v36 offset:12288
    ds_read_b64_tr_b16 v[142:143], v36 offset:14336
    s_waitcnt lgkmcnt(4)
    ds_read_b64_tr_b16 v[144:145], v37 offset:0
    ds_read_b64_tr_b16 v[146:147], v37 offset:2048
    ds_read_b64_tr_b16 v[148:149], v37 offset:4096
    ds_read_b64_tr_b16 v[150:151], v37 offset:6144
    ds_read_b64_tr_b16 v[152:153], v37 offset:8192
    ds_read_b64_tr_b16 v[154:155], v37 offset:10240
    ds_read_b64_tr_b16 v[156:157], v37 offset:12288
    ds_read_b64_tr_b16 v[158:159], v37 offset:14336
    s_waitcnt lgkmcnt(4)
    ds_read_b64_tr_b16 v[160:161], v38 offset:0
    ds_read_b64_tr_b16 v[162:163], v38 offset:2048
    ds_read_b64_tr_b16 v[164:165], v38 offset:4096
    ds_read_b64_tr_b16 v[166:167], v38 offset:6144
    ds_read_b64_tr_b16 v[168:169], v38 offset:8192
    ds_read_b64_tr_b16 v[170:171], v38 offset:10240
    ds_read_b64_tr_b16 v[172:173], v38 offset:12288
    ds_read_b64_tr_b16 v[174:175], v38 offset:14336
    s_waitcnt lgkmcnt(4)
    ds_read_b64_tr_b16 v[176:177], v39 offset:0
    ds_read_b64_tr_b16 v[178:179], v39 offset:2048
    ds_read_b64_tr_b16 v[180:181], v39 offset:4096
    ds_read_b64_tr_b16 v[182:183], v39 offset:6144
    ds_read_b64_tr_b16 v[184:185], v39 offset:8192
    ds_read_b64_tr_b16 v[186:187], v39 offset:10240
    ds_read_b64_tr_b16 v[188:189], v39 offset:12288
    ds_read_b64_tr_b16 v[190:191], v39 offset:14336
    s_waitcnt lgkmcnt(4)
    s_cmp_lt_u32 s7, 4
    s_cbranch_scc1 L_h_nod
    s_sleep 12
L_h_nod:
    buffer_load_dwordx4 v[232:235], v16, s[36:39], s56 offen offset:0 sc1
    buffer_load_dwordx4 v[236:239], v16, s[36:39], s56 offen offset:256 sc1
    buffer_load_dwordx4 v[240:243], v16, s[36:39], s57 offen offset:0 sc1
    buffer_load_dwordx4 v[244:247], v16, s[36:39], s57 offen offset:256 sc1
    s_sleep 4
    s_branch L_h_in
L_h_retry:
    buffer_load_dwordx4 v[232:235], v16, s[36:39], s56 offen offset:0 sc1
    buffer_load_dwordx4 v[236:239], v16, s[36:39], s56 offen offset:256 sc1
    buffer_load_dwordx4 v[240:243], v16, s[36:39], s57 offen offset:0 sc1
    buffer_load_dwordx4 v[244:247], v16, s[36:39], s57 offen offset:256 sc1
L_h_in:
    s_waitcnt vmcnt(0) lgkmcnt(0)
    v_xor_b32 v40, s73, v233
    v_xor_b32 v41, s73, v235
    v_xor_b32 v42, s73, v237
    v_xor_b32 v43, s73, v239
    v_xor_b32 v44, s73, v241
    v_xor_b32 v45, s73, v243
    v_xor_b32 v46, s73, v245
    v_xor_b32 v47, s73, v247
    v_or3_b32 v1, v40, v41, v42
    v_or3_b32 v6, v43, v44, v45
    v_or3_b32 v1, v1, v46, v47
    v_or_b32 v1, v1, v6
    v_cmp_ne_u32 vcc, 0, v1
    s_cbranch_vccz L_h_ok
    s_add_u32 s79, s79, 1
    s_cmp_lt_u32 s79, 65536
    s_cbranch_scc1 L_h_retry
L_h_ok:
    v_and_b32 v41, s83, v232
    v_lshlrev_b32 v40, 16, v232
    v_and_b32 v43, s83, v234
    v_lshlrev_b32 v42, 16, v234
    v_and_b32 v45, s83, v236
    v_lshlrev_b32 v44, 16, v236
    v_and_b32 v47, s83, v238
    v_lshlrev_b32 v46, 16, v238
    v_and_b32 v49, s83, v240
    v_lshlrev_b32 v48, 16, v240
    v_and_b32 v51, s83, v242
    v_lshlrev_b32 v50, 16, v242
    v_and_b32 v53, s83, v244
    v_lshlrev_b32 v52, 16, v244
    v_and_b32 v55, s83, v246
    v_lshlrev_b32 v54, 16, v246
    v_pk_mul_f32 v[48:49], v[48:49], v[216:217]
    v_pk_mul_f32 v[50:51], v[50:51], v[218:219]
    v_pk_mul_f32 v[52:53], v[52:53], v[220:221]
    v_pk_mul_f32 v[54:55], v[54:55], v[222:223]
    v_cvt_pk_bf16_f32 v56, v48, v49
    v_cvt_pk_bf16_f32 v57, v50, v51
    v_cvt_pk_bf16_f32 v58, v52, v53
    v_cvt_pk_bf16_f32 v59, v54, v55
    v_lshlrev_b32 v48, 16, v56
    v_and_b32 v49, s83, v56
    v_lshlrev_b32 v50, 16, v57
    v_and_b32 v51, s83, v57
    v_lshlrev_b32 v52, 16, v58
    v_and_b32 v53, s83, v58
    v_lshlrev_b32 v54, 16, v59
    v_and_b32 v55, s83, v59
    v_pk_add_f32 v[40:41], v[40:41], v[48:49]
    v_pk_add_f32 v[42:43], v[42:43], v[50:51]
    v_pk_add_f32 v[44:45], v[44:45], v[52:53]
    v_pk_add_f32 v[46:47], v[46:47], v[54:55]
    v_cvt_pk_bf16_f32 v48, v40, v41
    v_cvt_pk_bf16_f32 v49, v42, v43
    v_cvt_pk_bf16_f32 v50, v44, v45
    v_cvt_pk_bf16_f32 v51, v46, v47
    v_mov_b32_dpp v52, v48 row_ror:4 row_mask:0xf bank_mask:0xf
    v_mov_b32_dpp v53, v49 row_ror:4 row_mask:0xf bank_mask:0xf
    v_mov_b32_dpp v54, v50 row_ror:4 row_mask:0xf bank_mask:0xf
    v_mov_b32_dpp v55, v51 row_ror:4 row_mask:0xf bank_mask:0xf
    v_mov_b32_dpp v56, v48 row_ror:8 row_mask:0xf bank_mask:0xf
    v_mov_b32_dpp v57, v49 row_ror:8 row_mask:0xf bank_mask:0xf
    v_mov_b32_dpp v58, v50 row_ror:8 row_mask:0xf bank_mask:0xf
    v_mov_b32_dpp v59, v51 row_ror:8 row_mask:0xf bank_mask:0xf
    v_mov_b32_dpp v60, v48 row_ror:12 row_mask:0xf bank_mask:0xf
    v_mov_b32_dpp v61, v49 row_ror:12 row_mask:0xf bank_mask:0xf
    v_mov_b32_dpp v62, v50 row_ror:12 row_mask:0xf bank_mask:0xf
    v_mov_b32_dpp v63, v51 row_ror:12 row_mask:0xf bank_mask:0xf
    v_mfma_f32_16x16x32_bf16 v[200:203], v[128:131], v[48:51], 0
    v_mfma_f32_16x16x32_bf16 v[204:207], v[148:151], v[48:51], 0
    buffer_load_dwordx4 v[64:67], v2, s[40:43], s76 offen offset:0 nt
    v_mfma_f32_16x16x32_bf16 v[208:211], v[168:171], v[48:51], 0
    v_mfma_f32_16x16x32_bf16 v[212:215], v[188:191], v[48:51], 0
    buffer_load_dwordx4 v[68:71], v2, s[40:43], s76 offen offset:256 nt
    v_mfma_f32_16x16x32_bf16 v[200:203], v[140:143], v[52:55], v[200:203]
    v_mfma_f32_16x16x32_bf16 v[204:207], v[144:147], v[52:55], v[204:207]
    buffer_load_dwordx4 v[72:75], v2, s[40:43], s76 offen offset:512 nt
    v_mfma_f32_16x16x32_bf16 v[208:211], v[164:167], v[52:55], v[208:211]
    v_mfma_f32_16x16x32_bf16 v[212:215], v[184:187], v[52:55], v[212:215]
    buffer_load_dwordx4 v[76:79], v2, s[40:43], s76 offen offset:768 nt
    v_mfma_f32_16x16x32_bf16 v[200:203], v[136:139], v[56:59], v[200:203]
    v_mfma_f32_16x16x32_bf16 v[204:207], v[156:159], v[56:59], v[204:207]
    s_add_u32 s97, s76, 131072
    buffer_load_dwordx4 v[80:83], v2, s[40:43], s97 offen offset:0 nt
    v_mfma_f32_16x16x32_bf16 v[208:211], v[160:163], v[56:59], v[208:211]
    v_mfma_f32_16x16x32_bf16 v[212:215], v[180:183], v[56:59], v[212:215]
    buffer_load_dwordx4 v[84:87], v2, s[40:43], s97 offen offset:256 nt
    v_mfma_f32_16x16x32_bf16 v[200:203], v[132:135], v[60:63], v[200:203]
    v_mfma_f32_16x16x32_bf16 v[204:207], v[152:155], v[60:63], v[204:207]
    buffer_load_dwordx4 v[88:91], v2, s[40:43], s97 offen offset:512 nt
    v_mfma_f32_16x16x32_bf16 v[208:211], v[172:175], v[60:63], v[208:211]
    v_mfma_f32_16x16x32_bf16 v[212:215], v[176:179], v[60:63], v[212:215]
    buffer_load_dwordx4 v[92:95], v2, s[40:43], s97 offen offset:768 nt
    s_mov_b32 exec_lo, 0xf000f
    s_mov_b32 exec_hi, 0xf000f
    s_nop 0
    ds_write_b128 v18, v[200:203]
    s_mov_b32 exec_lo, 0xf000f0
    s_mov_b32 exec_hi, 0xf000f0
    ds_write_b128 v18, v[204:207]
    s_mov_b32 exec_lo, 0xf000f00
    s_mov_b32 exec_hi, 0xf000f00
    ds_write_b128 v18, v[208:211]
    s_mov_b32 exec_lo, 0xf000f000
    s_mov_b32 exec_hi, 0xf000f000
    ds_write_b128 v18, v[212:215]
    s_mov_b64 exec, -1
    s_waitcnt lgkmcnt(0)
    s_barrier
    s_barrier
    s_branch L_stream
L_exit:
L_last:
    s_endpgm
.section .rodata,"a"
.p2align 6
.amdhsa_kernel adaLN_cond__sliding_block_cached__glu_gated_glu__decode_kernel
  .amdhsa_next_free_vgpr 252
  .amdhsa_next_free_sgpr 102
  .amdhsa_accum_offset 252
  .amdhsa_group_segment_fixed_size 0
  .amdhsa_kernarg_size 112
  .amdhsa_user_sgpr_count 2
  .amdhsa_user_sgpr_kernarg_segment_ptr 1
  .amdhsa_system_sgpr_workgroup_id_x 1
  .amdhsa_float_denorm_mode_32 3
.end_amdhsa_kernel
```
